```python
import torch

def _softmax(x, axis=-1):
    return torch.softmax(x, dim=axis)
def _gelu(x):
    return torch.nn.functional.gelu(x, approximate="tanh")
def _silu(x):
    return torch.nn.functional.silu(x)
def _sigmoid(x):
    return torch.sigmoid(x)
def _layernorm(x, axis=-1, eps=1e-5):
    m = x.mean(dim=axis, keepdim=True)
    v = x.var(dim=axis, keepdim=True, unbiased=False)
    return (x - m) / torch.sqrt(v + eps)
def _scatter_add(tgt, idx, src, axis=0):
    return tgt.clone().index_add_(axis, idx, src)
def _segment_sum(src, seg, n):
    out = torch.zeros((n,) + src.shape[1:], dtype=src.dtype)
    return out.index_add_(0, seg, src)
def _pad(x, pw):
    flat = tuple(v for pair in reversed(pw) for v in pair)
    return torch.nn.functional.pad(x, flat)

kernel_name = 'sequential_preLN__linear_attn_block__swiglu_ffn__prompt'

def setup_inputs():

    _w = (lambda a: (lambda t: t.to(torch.bfloat16) if t.is_floating_point() else t)(torch.as_tensor(a)))
    def _A_setup():
        B, S, D = 1, 2048, 448
        return {
            "x": _w((lambda *s: torch.randn(*s, dtype=torch.bfloat16) * 0.05)(B, S, D)),
            "wqkv": _w((lambda *s: torch.randn(*s, dtype=torch.bfloat16) * 0.1)(D, 3 * D)),
            "wo": _w((lambda *s: torch.randn(*s, dtype=torch.bfloat16) * 0.05)(D, D)),
        }
    _A_in = _A_setup()

    def _B_setup():
        B, S, D, F = 1, 2048, 448, 1792
        return {
            "x": _w((lambda *s: torch.randn(*s, dtype=torch.bfloat16) * 0.05)(B, S, D)),
            "w_gate": _w((lambda *s: torch.randn(*s, dtype=torch.bfloat16) * 0.05)(D, F)),
            "w_up": _w((lambda *s: torch.randn(*s, dtype=torch.bfloat16) * 0.05)(D, F)),
            "w_down": _w((lambda *s: torch.randn(*s, dtype=torch.bfloat16) * 0.05)(F, D)),
        }
    _B_in = _B_setup()

    return {
        "A_x": _A_in["x"],
        "A_wqkv": _A_in["wqkv"],
        "A_wo": _A_in["wo"],
        "B_x": _B_in["x"],
        "B_w_gate": _B_in["w_gate"],
        "B_w_up": _B_in["w_up"],
        "B_w_down": _B_in["w_down"],
    }

def reference(A_x, A_wqkv, A_wo, B_x, B_w_gate, B_w_up, B_w_down):
    def _A_ref(x, wqkv, wo):
        B, S, D = x.shape
        H = 16; Dh = D // H
        qkv = (lambda x, *d: x.permute(*d))((x @ wqkv).reshape(B, S, 3, H, Dh), 2, 0, 3, 1, 4)
        q, k, v = qkv[0], qkv[1], qkv[2]
        phi = lambda t: torch.where(t > 0, t + 1, torch.exp(t)) + 1e-6
        pq, pk = phi(q), phi(k)
        kv = torch.einsum("bhsd,bhse->bhde", pk, v)
        z = torch.einsum("bhsd->bhd", pk)
        num = torch.einsum("bhqd,bhde->bhqe", pq, kv)
        den = torch.einsum("bhqd,bhd->bhq", pq, z)[..., None] + 1e-6
        o = num / den
        return (lambda x, *d: x.permute(*d))(o, 0, 2, 1, 3).reshape(B, S, D) @ wo

    def _B_ref(x, w_gate, w_up, w_down):
        g = _silu(x @ w_gate)
        u = x @ w_up
        return (g * u) @ w_down

    x = A_x
    h = x + _A_ref(_layernorm(x, axis=-1), A_wqkv, A_wo)
    h2 = h + _B_ref(_layernorm(h, axis=-1), B_w_gate, B_w_up, B_w_down)
    return h2
```

```asm
; @launch grid=(256,1,1) block=(512,1,1) lds=163840
.amdgcn_target "amdgcn-amd-amdhsa--gfx950"
.text
.globl sequential_preLN__linear_attn_block__swiglu_ffn__prompt_kernel
.p2align 8
.type sequential_preLN__linear_attn_block__swiglu_ffn__prompt_kernel,@function
sequential_preLN__linear_attn_block__swiglu_ffn__prompt_kernel:
    s_cmp_ge_u32 s2, 256
    s_cbranch_scc1 Lka_end
    s_load_dwordx2 s[4:5], s[0:1], 0
    s_load_dwordx2 s[8:9], s[0:1], 8
    s_load_dwordx2 s[16:17], s[0:1], 64
    s_load_dwordx2 s[12:13], s[0:1], 72
    s_load_dwordx2 s[32:33], s[0:1], 16
    v_lshrrev_b32 v5, 6, v0
    v_lshrrev_b32 v6, 3, v0
    v_readfirstlane_b32 s20, v5
    v_and_b32 v7, 0x38, v6
    v_add_u32 v7, v6, v7
    v_and_b32 v8, 7, v0
    v_bfe_u32 v9, v0, 4, 2
    v_xor_b32 v9, v8, v9
    v_mul_u32_u24 v1, 896, v7
    v_lshl_add_u32 v1, v9, 4, v1
    v_xor_b32 v2, 64, v1
    v_add_u32 v2, 6144, v2
    s_bfe_u32 s21, s2, 0x20001
    s_lshl_b32 s21, s21, 2
    s_lshr_b32 s26, s2, 6
    s_add_u32 s21, s21, s26
    s_bfe_u32 s27, s2, 0x30003
    s_and_b32 s22, s2, 1
    s_lshl_b32 s22, s22, 3
    s_add_u32 s22, s22, s27
    s_lshl_b32 s26, s26, 1
    s_add_u32 s26, s26, s27
    s_mul_i32 s27, s26, 37
    s_lshr_b32 s27, s27, 8
    s_mul_i32 s77, s27, 7
    s_sub_u32 s77, s26, s77
    s_mul_i32 s23, s21, 114688
    s_lshl_b32 s26, s77, 7
    s_add_u32 s23, s23, s26
    s_mov_b32 s31, s77
    s_lshl_b32 m0, s20, 11
    s_mov_b32 s6, 1835008
    s_mov_b32 s7, 0x20000
    s_mov_b32 s10, 1204224
    s_mov_b32 s11, 0x20000
    s_mov_b32 s34, 401408
    s_mov_b32 s35, 0x20000
    v_and_b32 v5, 63, v0
    v_min_u32 v11, 36, v5
    s_mul_i32 s26, s2, 37
    v_add_lshl_u32 v11, v11, s26, 7
    s_waitcnt lgkmcnt(0)
    s_mov_b32 s14, 11730944
    s_mov_b32 s15, 0x20000
    s_lshr_b32 s78, s2, 6
    s_lshl_b32 s78, s78, 3
    s_bfe_u32 s26, s2, 0x30001
    s_add_u32 s78, s78, s26
    s_and_b32 s26, s2, 0x31
    s_cmp_lg_u32 s26, 0
    s_cselect_b32 s78, 63, s78
    s_cmp_ge_u32 s78, 24
    s_cbranch_scc1 Lka_nozero
    s_cmp_ge_u32 s78, 8
    s_cselect_b32 s26, 11517952, 0
    s_cmp_ge_u32 s78, 22
    s_cselect_b32 s26, 4046848, s26
    s_cselect_b32 s27, -1, 0
    v_mov_b32 v12, s27
    v_mov_b32 v13, s27
    v_mov_b32 v14, s27
    v_mov_b32 v15, s27
    s_lshl_b32 s27, s78, 13
    s_add_u32 s26, s26, s27
    v_lshlrev_b32 v10, 4, v0
    buffer_store_dwordx4 v[12:15], v10, s[12:15], s26 offen sc1
Lka_nozero:
    buffer_load_dwordx4 v1, s[4:7], s23 offen lds
    buffer_load_dwordx4 v2, s[4:7], s23 offen offset:1024 lds
    s_barrier
    s_lshl_b32 s26, s20, 11
    s_add_u32 m0, s26, 16384
    s_add_u32 s31, s31, 1
    s_cmp_eq_u32 s31, 7
    s_cselect_b32 s26, -6, 1
    s_lshl_b32 s26, s26, 7
    s_add_u32 s23, s23, s26
    buffer_load_dwordx4 v1, s[4:7], s23 offen lds
    buffer_load_dwordx4 v2, s[4:7], s23 offen offset:1024 lds
    s_cmp_lg_u32 s20, 3
    s_cbranch_scc1 Lka_nt1
    buffer_load_dword v190, v11, s[8:11], 0 offen
Lka_nt1:
    s_getpc_b64 s[36:37]
    Lka_pc:
    s_lshr_b32 s27, s2, 3
    v_min_u32 v5, 7, v0
    v_lshlrev_b32 v5, 7, v5
    s_mul_i32 s26, s27, 1024
    v_add_u32 v5, s26, v5
    v_min_u32 v5, Lcode_end-Lka_pc-4, v5
    v_cmp_gt_u32 vcc, 8, v0
    s_and_saveexec_b64 s[38:39], vcc
    s_cbranch_execz Lka_nocpf
    global_load_dword v190, v5, s[36:37]
Lka_nocpf:
    s_mov_b64 exec, -1
    v_bfe_u32 v9, v0, 4, 1
    v_lshlrev_b32 v9, 2, v9
    v_xor_b32 v9, v8, v9
    v_mul_u32_u24 v3, 2688, v6
    v_and_b32 v8, 3, v9
    v_lshl_add_u32 v3, v8, 4, v3
    v_lshrrev_b32 v9, 2, v9
    v_mul_u32_u24 v9, 896, v9
    v_add_u32 v3, v3, v9
    s_mul_i32 s25, s22, 56
    s_and_b32 s25, s25, -16
    s_mul_i32 s26, s77, 172032
    s_add_u32 s24, s25, s26
    s_add_u32 s24, s24, 896
    s_mov_b32 s76, s77
    s_xor_b32 s25, s22, 1
    s_mul_i32 s25, s25, 56
    s_and_b32 s25, s25, -16
    s_barrier
    s_lshl_b32 s26, s20, 11
    s_add_u32 m0, s26, 32768
    s_add_u32 s31, s31, 1
    s_cmp_eq_u32 s31, 7
    s_cselect_b32 s26, -6, 1
    s_lshl_b32 s26, s26, 7
    s_add_u32 s23, s23, s26
    buffer_load_dwordx4 v1, s[4:7], s23 offen lds
    buffer_load_dwordx4 v2, s[4:7], s23 offen offset:1024 lds
    s_lshl_b32 s26, s20, 10
    s_add_u32 m0, s26, 114688
    s_nop 0
    buffer_load_dwordx4 v3, s[8:11], s24 offen lds
    s_load_dwordx2 s[56:57], s[0:1], 32
    s_load_dwordx2 s[60:61], s[0:1], 40
    s_load_dwordx2 s[64:65], s[0:1], 48
    s_load_dwordx2 s[68:69], s[0:1], 56
    s_mov_b32 s18, 256
    s_mov_b32 s19, 0x20000
    s_mov_b32 s28, 0x35c1a2a0
    s_mov_b32 s29, 0x3f803f80
    s_mov_b32 s30, 0x3f317218
    v_mov_b32 v12, 0
    v_mov_b32 v13, 0
    v_mov_b32 v14, 0
    v_mov_b32 v15, 0
    v_mov_b32 v10, 161792
    ds_write_b128 v10, v[12:15]
    ds_write_b128 v10, v[12:15] offset:16
    s_cmp_lt_u32 s20, 8
    s_cbranch_scc1 Lka_nozf
    v_and_b32 v10, 255, v0
    v_lshlrev_b32 v10, 4, v10
    s_lshr_b32 s26, s21, 2
    s_or_b32 s26, s26, s22
    s_cmp_lg_u32 s26, 0
    s_cbranch_scc1 Lka_nocs
    s_lshl_b32 s26, s21, 12
    s_add_u32 s26, s26, 4227072
    v_mov_b32 v16, -1
    v_mov_b32 v17, -1
    v_mov_b32 v18, -1
    v_mov_b32 v19, -1
    buffer_store_dwordx4 v[16:19], v10, s[12:15], s26 offen sc1
Lka_nocs:
    s_cmp_lg_u32 s22, 14
    s_cbranch_scc1 Lka_nozf
    s_lshl_b32 s26, s21, 12
    s_add_u32 s26, s26, 11583488
    buffer_store_dwordx4 v[12:15], v10, s[12:15], s26 offen sc1
Lka_nozf:
    v_and_b32 v8, 31, v0
    v_bfe_u32 v9, v0, 5, 1
    v_bfe_u32 v14, v0, 6, 2
    v_lshl_add_u32 v15, v14, 5, v8
    v_lshlrev_b32 v10, 7, v15
    v_bfe_u32 v11, v8, 1, 3
    v_xor_b32 v11, v11, v9
    v_lshlrev_b32 v12, 1, v14
    v_xor_b32 v11, v11, v12
    v_mov_b32 v7, 1
    v_xor_b32 v12, 0, v11
    v_lshl_add_u32 v172, v12, 4, v10
    v_xor_b32 v12, 2, v11
    v_lshl_add_u32 v173, v12, 4, v10
    v_xor_b32 v12, 4, v11
    v_lshl_add_u32 v174, v12, 4, v10
    v_xor_b32 v12, 6, v11
    v_lshl_add_u32 v175, v12, 4, v10
    v_add_u32 v176, 0x10000, v172
    v_add_u32 v177, 0x10000, v173
    v_add_u32 v178, 0x10000, v174
    v_add_u32 v179, 0x10000, v175
    v_mov_b32 v6, 161792
    s_waitcnt lgkmcnt(0)
    s_cmp_ge_u32 s20, 4
    s_cbranch_scc1 Lka_q
    s_setprio 2
    v_bfe_u32 v11, v0, 2, 2
    v_lshl_add_u32 v10, v9, 3, v11
    v_lshlrev_b32 v10, 7, v10
    v_bfe_u32 v12, v0, 4, 1
    v_and_b32 v13, 3, v0
    v_lshl_add_u32 v12, v12, 2, v13
    s_and_b32 s26, s22, 1
    v_add_u32 v12, s26, v12
    v_and_b32 v12, 7, v12
    v_lshl_add_u32 v10, v12, 3, v10
    v_lshrrev_b32 v11, 1, v11
    v_lshl_add_u32 v10, v11, 6, v10
    v_lshl_add_u32 v10, v14, 11, v10
    v_add_u32 v152, 114688, v10
    v_mov_b32 v160, 0
    v_mov_b32 v161, 0
    v_mov_b32 v102, 0
    v_mov_b32 v103, 0
    v_xor_b32 v153, 2048, v152
    v_xor_b32 v154, 4096, v152
    v_xor_b32 v155, 6144, v152
    v_xor_b32 v156, 64, v152
    v_xor_b32 v157, 64, v153
    v_xor_b32 v158, 64, v154
    v_xor_b32 v159, 64, v155
    v_lshlrev_b32 v12, 3, v0
    v_add_u32 v12, 157696, v12
    v_and_b32 v13, 63, v0
    v_lshlrev_b32 v13, 3, v13
    v_add_u32 v13, 157696, v13
    v_lshlrev_b32 v10, 3, v15
    v_add_u32 v10, 155648, v10
    v_lshlrev_b32 v11, 7, v14
    v_lshl_add_u32 v11, v9, 4, v11
    v_add_u32 v11, 156672, v11
    s_waitcnt vmcnt(5)
    s_barrier
    s_lshl_b32 s26, s20, 11
    s_add_u32 m0, s26, 49152
    s_add_u32 s31, s31, 1
    s_cmp_eq_u32 s31, 7
    s_cselect_b32 s26, -6, 1
    s_lshl_b32 s26, s26, 7
    s_add_u32 s23, s23, s26
    buffer_load_dwordx4 v1, s[4:7], s23 offen lds
    buffer_load_dwordx4 v2, s[4:7], s23 offen offset:1024 lds
    s_lshl_b32 s26, s20, 10
    s_add_u32 m0, s26, 122880
    s_add_u32 s76, s76, 1
    s_cmp_eq_u32 s76, 7
    s_cselect_b32 s26, -6, 1
    s_mul_i32 s26, s26, 172032
    s_add_u32 s24, s24, s26
    buffer_load_dwordx4 v3, s[8:11], s24 offen lds
    s_waitcnt vmcnt(6)
    s_barrier
    s_lshl_b32 s26, s20, 11
    s_add_u32 m0, s26, 65536
    s_add_u32 s31, s31, 1
    s_cmp_eq_u32 s31, 7
    s_cselect_b32 s26, -6, 1
    s_lshl_b32 s26, s26, 7
    s_add_u32 s23, s23, s26
    buffer_load_dwordx4 v1, s[4:7], s23 offen lds
    buffer_load_dwordx4 v2, s[4:7], s23 offen offset:1024 lds
    s_lshl_b32 s26, s20, 10
    s_add_u32 m0, s26, 131072
    s_add_u32 s76, s76, 1
    s_cmp_eq_u32 s76, 7
    s_cselect_b32 s26, -6, 1
    s_mul_i32 s26, s26, 172032
    s_add_u32 s24, s24, s26
    buffer_load_dwordx4 v3, s[8:11], s24 offen lds
    s_waitcnt vmcnt(6)
    s_barrier
    ds_read_b128 v[48:51], v172 offset:0
    ds_read_b64_tr_b16 v[52:53], v152 offset:0
    ds_read_b64_tr_b16 v[54:55], v152 offset:512
    ds_read_b64_tr_b16 v[56:57], v156 offset:0
    ds_read_b64_tr_b16 v[58:59], v156 offset:512
    s_lshl_b32 s26, s20, 11
    s_add_u32 m0, s26, 81920
    s_add_u32 s31, s31, 1
    s_cmp_eq_u32 s31, 7
    s_cselect_b32 s26, -6, 1
    s_lshl_b32 s26, s26, 7
    s_add_u32 s23, s23, s26
    buffer_load_dwordx4 v1, s[4:7], s23 offen lds
    buffer_load_dwordx4 v2, s[4:7], s23 offen offset:1024 lds
    s_lshl_b32 s26, s20, 10
    s_add_u32 m0, s26, 139264
    s_add_u32 s76, s76, 1
    s_cmp_eq_u32 s76, 7
    s_cselect_b32 s26, -6, 1
    s_mul_i32 s26, s26, 172032
    s_add_u32 s24, s24, s26
    buffer_load_dwordx4 v3, s[8:11], s24 offen lds
    ds_read_b128 v[60:63], v173 offset:0
    ds_read_b64_tr_b16 v[64:65], v153 offset:0
    ds_read_b64_tr_b16 v[66:67], v153 offset:512
    ds_read_b64_tr_b16 v[68:69], v157 offset:0
    ds_read_b64_tr_b16 v[70:71], v157 offset:512
    ds_read_b128 v[72:75], v174 offset:0
    ds_read_b64_tr_b16 v[76:77], v154 offset:0
    ds_read_b64_tr_b16 v[78:79], v154 offset:512
    ds_read_b64_tr_b16 v[80:81], v158 offset:0
    ds_read_b64_tr_b16 v[82:83], v158 offset:512
    s_waitcnt lgkmcnt(10)
    v_mfma_f32_32x32x16_bf16 v[16:31], v[48:51], v[52:55], 0
    v_mfma_f32_32x32x16_bf16 v[32:47], v[48:51], v[56:59], 0
    v_dot2c_f32_bf16 v160, s29, v52
    v_dot2c_f32_bf16 v161, s29, v56
    v_dot2c_f32_bf16 v160, s29, v53
    v_dot2c_f32_bf16 v161, s29, v57
    v_dot2c_f32_bf16 v160, s29, v54
    v_dot2c_f32_bf16 v161, s29, v58
    v_dot2c_f32_bf16 v160, s29, v55
    v_dot2c_f32_bf16 v161, s29, v59
    ds_read_b128 v[48:51], v175 offset:0
    ds_read_b64_tr_b16 v[52:53], v155 offset:0
    ds_read_b64_tr_b16 v[54:55], v155 offset:512
    ds_read_b64_tr_b16 v[56:57], v159 offset:0
    ds_read_b64_tr_b16 v[58:59], v159 offset:512
    s_waitcnt lgkmcnt(10)
    v_mfma_f32_32x32x16_bf16 v[16:31], v[60:63], v[64:67], v[16:31]
    v_mfma_f32_32x32x16_bf16 v[32:47], v[60:63], v[68:71], v[32:47]
    s_waitcnt vmcnt(6)
    s_barrier
    ds_read_b128 v[60:63], v172 offset:16384
    ds_read_b64_tr_b16 v[64:65], v152 offset:8192
    ds_read_b64_tr_b16 v[66:67], v152 offset:8704
    ds_read_b64_tr_b16 v[68:69], v156 offset:8192
    ds_read_b64_tr_b16 v[70:71], v156 offset:8704
    s_lshl_b32 s26, s20, 11
    s_add_u32 m0, s26, 98304
    s_add_u32 s31, s31, 1
    s_cmp_eq_u32 s31, 7
    s_cselect_b32 s26, -6, 1
    s_lshl_b32 s26, s26, 7
    s_add_u32 s23, s23, s26
    buffer_load_dwordx4 v1, s[4:7], s23 offen lds
    buffer_load_dwordx4 v2, s[4:7], s23 offen offset:1024 lds
    s_lshl_b32 s26, s20, 10
    s_add_u32 m0, s26, 147456
    s_add_u32 s76, s76, 1
    s_cmp_eq_u32 s76, 7
    s_cselect_b32 s26, -6, 1
    s_mul_i32 s26, s26, 172032
    s_add_u32 s24, s24, s26
    buffer_load_dwordx4 v3, s[8:11], s24 offen lds
    s_waitcnt lgkmcnt(10)
    v_mfma_f32_32x32x16_bf16 v[16:31], v[72:75], v[76:79], v[16:31]
    v_mfma_f32_32x32x16_bf16 v[32:47], v[72:75], v[80:83], v[32:47]
    ds_read_b128 v[72:75], v173 offset:16384
    ds_read_b64_tr_b16 v[76:77], v153 offset:8192
    ds_read_b64_tr_b16 v[78:79], v153 offset:8704
    ds_read_b64_tr_b16 v[80:81], v157 offset:8192
    ds_read_b64_tr_b16 v[82:83], v157 offset:8704
    s_waitcnt lgkmcnt(10)
    v_mfma_f32_32x32x16_bf16 v[16:31], v[48:51], v[52:55], v[16:31]
    v_mfma_f32_32x32x16_bf16 v[32:47], v[48:51], v[56:59], v[32:47]
    ds_read_b128 v[48:51], v174 offset:16384
    ds_read_b64_tr_b16 v[52:53], v154 offset:8192
    ds_read_b64_tr_b16 v[54:55], v154 offset:8704
    ds_read_b64_tr_b16 v[56:57], v158 offset:8192
    ds_read_b64_tr_b16 v[58:59], v158 offset:8704
    s_waitcnt lgkmcnt(10)
    v_mfma_f32_32x32x16_bf16 v[16:31], v[60:63], v[64:67], v[16:31]
    v_mfma_f32_32x32x16_bf16 v[32:47], v[60:63], v[68:71], v[32:47]
    v_dot2c_f32_bf16 v160, s29, v64
    v_dot2c_f32_bf16 v161, s29, v68
    v_dot2c_f32_bf16 v160, s29, v65
    v_dot2c_f32_bf16 v161, s29, v69
    v_dot2c_f32_bf16 v160, s29, v66
    v_dot2c_f32_bf16 v161, s29, v70
    v_dot2c_f32_bf16 v160, s29, v67
    v_dot2c_f32_bf16 v161, s29, v71
    ds_read_b128 v[60:63], v175 offset:16384
    ds_read_b64_tr_b16 v[64:65], v155 offset:8192
    ds_read_b64_tr_b16 v[66:67], v155 offset:8704
    ds_read_b64_tr_b16 v[68:69], v159 offset:8192
    ds_read_b64_tr_b16 v[70:71], v159 offset:8704
    s_waitcnt lgkmcnt(10)
    v_mfma_f32_32x32x16_bf16 v[16:31], v[72:75], v[76:79], v[16:31]
    v_mfma_f32_32x32x16_bf16 v[32:47], v[72:75], v[80:83], v[32:47]
    s_waitcnt vmcnt(6)
    s_barrier
    ds_read_b128 v[72:75], v172 offset:32768
    ds_read_b64_tr_b16 v[76:77], v152 offset:16384
    ds_read_b64_tr_b16 v[78:79], v152 offset:16896
    ds_read_b64_tr_b16 v[80:81], v156 offset:16384
    ds_read_b64_tr_b16 v[82:83], v156 offset:16896
    s_lshl_b32 s26, s20, 10
    s_add_u32 m0, s26, 114688
    s_add_u32 s76, s76, 1
    s_cmp_eq_u32 s76, 7
    s_cselect_b32 s26, -6, 1
    s_mul_i32 s26, s26, 172032
    s_add_u32 s24, s24, s26
    buffer_load_dwordx4 v3, s[8:11], s24 offen lds
    s_waitcnt lgkmcnt(10)
    v_mfma_f32_32x32x16_bf16 v[16:31], v[48:51], v[52:55], v[16:31]
    v_mfma_f32_32x32x16_bf16 v[32:47], v[48:51], v[56:59], v[32:47]
    ds_read_b128 v[48:51], v173 offset:32768
    ds_read_b64_tr_b16 v[52:53], v153 offset:16384
    ds_read_b64_tr_b16 v[54:55], v153 offset:16896
    ds_read_b64_tr_b16 v[56:57], v157 offset:16384
    ds_read_b64_tr_b16 v[58:59], v157 offset:16896
    s_waitcnt lgkmcnt(10)
    v_mfma_f32_32x32x16_bf16 v[16:31], v[60:63], v[64:67], v[16:31]
    v_mfma_f32_32x32x16_bf16 v[32:47], v[60:63], v[68:71], v[32:47]
    ds_read_b128 v[60:63], v174 offset:32768
    ds_read_b64_tr_b16 v[64:65], v154 offset:16384
    ds_read_b64_tr_b16 v[66:67], v154 offset:16896
    ds_read_b64_tr_b16 v[68:69], v158 offset:16384
    ds_read_b64_tr_b16 v[70:71], v158 offset:16896
    s_waitcnt lgkmcnt(10)
    v_mfma_f32_32x32x16_bf16 v[16:31], v[72:75], v[76:79], v[16:31]
    v_mfma_f32_32x32x16_bf16 v[32:47], v[72:75], v[80:83], v[32:47]
    v_dot2c_f32_bf16 v160, s29, v76
    v_dot2c_f32_bf16 v161, s29, v80
    v_dot2c_f32_bf16 v160, s29, v77
    v_dot2c_f32_bf16 v161, s29, v81
    v_dot2c_f32_bf16 v160, s29, v78
    v_dot2c_f32_bf16 v161, s29, v82
    v_dot2c_f32_bf16 v160, s29, v79
    v_dot2c_f32_bf16 v161, s29, v83
    ds_read_b128 v[72:75], v175 offset:32768
    ds_read_b64_tr_b16 v[76:77], v155 offset:16384
    ds_read_b64_tr_b16 v[78:79], v155 offset:16896
    ds_read_b64_tr_b16 v[80:81], v159 offset:16384
    ds_read_b64_tr_b16 v[82:83], v159 offset:16896
    s_waitcnt lgkmcnt(10)
    v_mfma_f32_32x32x16_bf16 v[16:31], v[48:51], v[52:55], v[16:31]
    v_mfma_f32_32x32x16_bf16 v[32:47], v[48:51], v[56:59], v[32:47]
    s_waitcnt vmcnt(4)
    s_barrier
    ds_read_b128 v[48:51], v172 offset:49152
    ds_read_b64_tr_b16 v[52:53], v152 offset:24576
    ds_read_b64_tr_b16 v[54:55], v152 offset:25088
    ds_read_b64_tr_b16 v[56:57], v156 offset:24576
    ds_read_b64_tr_b16 v[58:59], v156 offset:25088
    s_lshl_b32 s26, s20, 10
    s_add_u32 m0, s26, 122880
    s_add_u32 s76, s76, 1
    s_cmp_eq_u32 s76, 7
    s_cselect_b32 s26, -6, 1
    s_mul_i32 s26, s26, 172032
    s_add_u32 s24, s24, s26
    buffer_load_dwordx4 v3, s[8:11], s24 offen lds
    s_waitcnt lgkmcnt(10)
    v_mfma_f32_32x32x16_bf16 v[16:31], v[60:63], v[64:67], v[16:31]
    v_mfma_f32_32x32x16_bf16 v[32:47], v[60:63], v[68:71], v[32:47]
    ds_read_b128 v[60:63], v173 offset:49152
    ds_read_b64_tr_b16 v[64:65], v153 offset:24576
    ds_read_b64_tr_b16 v[66:67], v153 offset:25088
    ds_read_b64_tr_b16 v[68:69], v157 offset:24576
    ds_read_b64_tr_b16 v[70:71], v157 offset:25088
    s_waitcnt lgkmcnt(10)
    v_mfma_f32_32x32x16_bf16 v[16:31], v[72:75], v[76:79], v[16:31]
    v_mfma_f32_32x32x16_bf16 v[32:47], v[72:75], v[80:83], v[32:47]
    ds_read_b128 v[72:75], v174 offset:49152
    ds_read_b64_tr_b16 v[76:77], v154 offset:24576
    ds_read_b64_tr_b16 v[78:79], v154 offset:25088
    ds_read_b64_tr_b16 v[80:81], v158 offset:24576
    ds_read_b64_tr_b16 v[82:83], v158 offset:25088
    s_waitcnt lgkmcnt(10)
    v_mfma_f32_32x32x16_bf16 v[16:31], v[48:51], v[52:55], v[16:31]
    v_mfma_f32_32x32x16_bf16 v[32:47], v[48:51], v[56:59], v[32:47]
    v_dot2c_f32_bf16 v160, s29, v52
    v_dot2c_f32_bf16 v161, s29, v56
    v_dot2c_f32_bf16 v160, s29, v53
    v_dot2c_f32_bf16 v161, s29, v57
    v_dot2c_f32_bf16 v160, s29, v54
    v_dot2c_f32_bf16 v161, s29, v58
    v_dot2c_f32_bf16 v160, s29, v55
    v_dot2c_f32_bf16 v161, s29, v59
    ds_read_b128 v[48:51], v175 offset:49152
    ds_read_b64_tr_b16 v[52:53], v155 offset:24576
    ds_read_b64_tr_b16 v[54:55], v155 offset:25088
    ds_read_b64_tr_b16 v[56:57], v159 offset:24576
    ds_read_b64_tr_b16 v[58:59], v159 offset:25088
    s_waitcnt lgkmcnt(10)
    v_mfma_f32_32x32x16_bf16 v[16:31], v[60:63], v[64:67], v[16:31]
    v_mfma_f32_32x32x16_bf16 v[32:47], v[60:63], v[68:71], v[32:47]
    s_waitcnt vmcnt(2)
    s_barrier
    ds_read_b128 v[60:63], v176 offset:0
    ds_read_b64_tr_b16 v[64:65], v152 offset:32768
    ds_read_b64_tr_b16 v[66:67], v152 offset:33280
    ds_read_b64_tr_b16 v[68:69], v156 offset:32768
    ds_read_b64_tr_b16 v[70:71], v156 offset:33280
    s_waitcnt lgkmcnt(10)
    v_mfma_f32_32x32x16_bf16 v[16:31], v[72:75], v[76:79], v[16:31]
    v_mfma_f32_32x32x16_bf16 v[32:47], v[72:75], v[80:83], v[32:47]
    ds_read_b128 v[72:75], v177 offset:0
    ds_read_b64_tr_b16 v[76:77], v153 offset:32768
    ds_read_b64_tr_b16 v[78:79], v153 offset:33280
    ds_read_b64_tr_b16 v[80:81], v157 offset:32768
    ds_read_b64_tr_b16 v[82:83], v157 offset:33280
    s_waitcnt lgkmcnt(10)
    v_mfma_f32_32x32x16_bf16 v[16:31], v[48:51], v[52:55], v[16:31]
    v_mfma_f32_32x32x16_bf16 v[32:47], v[48:51], v[56:59], v[32:47]
    ds_read_b128 v[48:51], v178 offset:0
    ds_read_b64_tr_b16 v[52:53], v154 offset:32768
    ds_read_b64_tr_b16 v[54:55], v154 offset:33280
    ds_read_b64_tr_b16 v[56:57], v158 offset:32768
    ds_read_b64_tr_b16 v[58:59], v158 offset:33280
    s_waitcnt lgkmcnt(10)
    v_mfma_f32_32x32x16_bf16 v[16:31], v[60:63], v[64:67], v[16:31]
    v_mfma_f32_32x32x16_bf16 v[32:47], v[60:63], v[68:71], v[32:47]
    v_dot2c_f32_bf16 v160, s29, v64
    v_dot2c_f32_bf16 v161, s29, v68
    v_dot2c_f32_bf16 v160, s29, v65
    v_dot2c_f32_bf16 v161, s29, v69
    v_dot2c_f32_bf16 v160, s29, v66
    v_dot2c_f32_bf16 v161, s29, v70
    v_dot2c_f32_bf16 v160, s29, v67
    v_dot2c_f32_bf16 v161, s29, v71
    ds_read_b128 v[60:63], v179 offset:0
    ds_read_b64_tr_b16 v[64:65], v155 offset:32768
    ds_read_b64_tr_b16 v[66:67], v155 offset:33280
    ds_read_b64_tr_b16 v[68:69], v159 offset:32768
    ds_read_b64_tr_b16 v[70:71], v159 offset:33280
    s_waitcnt lgkmcnt(10)
    v_mfma_f32_32x32x16_bf16 v[16:31], v[72:75], v[76:79], v[16:31]
    v_mfma_f32_32x32x16_bf16 v[32:47], v[72:75], v[80:83], v[32:47]
    s_waitcnt vmcnt(1)
    s_barrier
    ds_read_b128 v[72:75], v176 offset:16384
    ds_read_b64_tr_b16 v[76:77], v152 offset:0
    ds_read_b64_tr_b16 v[78:79], v152 offset:512
    ds_read_b64_tr_b16 v[80:81], v156 offset:0
    ds_read_b64_tr_b16 v[82:83], v156 offset:512
    v_mov_b32 v5, 0
    s_lshr_b32 s27, s22, 1
    s_lshl_b32 s27, s27, 2
    v_min_u32 v5, 23, v8
    v_lshlrev_b32 v5, 2, v5
    s_mov_b32 s27, 0
    buffer_load_dword v148, v5, s[16:19], s27 offen sc1
    s_waitcnt lgkmcnt(10)
    v_mfma_f32_32x32x16_bf16 v[16:31], v[48:51], v[52:55], v[16:31]
    v_mfma_f32_32x32x16_bf16 v[32:47], v[48:51], v[56:59], v[32:47]
    ds_read_b128 v[48:51], v177 offset:16384
    ds_read_b64_tr_b16 v[52:53], v153 offset:0
    ds_read_b64_tr_b16 v[54:55], v153 offset:512
    ds_read_b64_tr_b16 v[56:57], v157 offset:0
    ds_read_b64_tr_b16 v[58:59], v157 offset:512
    s_waitcnt lgkmcnt(10)
    v_mfma_f32_32x32x16_bf16 v[16:31], v[60:63], v[64:67], v[16:31]
    v_mfma_f32_32x32x16_bf16 v[32:47], v[60:63], v[68:71], v[32:47]
    ds_read_b128 v[60:63], v178 offset:16384
    ds_read_b64_tr_b16 v[64:65], v154 offset:0
    ds_read_b64_tr_b16 v[66:67], v154 offset:512
    ds_read_b64_tr_b16 v[68:69], v158 offset:0
    ds_read_b64_tr_b16 v[70:71], v158 offset:512
    s_waitcnt lgkmcnt(10)
    v_mfma_f32_32x32x16_bf16 v[16:31], v[72:75], v[76:79], v[16:31]
    v_mfma_f32_32x32x16_bf16 v[32:47], v[72:75], v[80:83], v[32:47]
    v_dot2c_f32_bf16 v160, s29, v76
    v_dot2c_f32_bf16 v161, s29, v80
    v_dot2c_f32_bf16 v160, s29, v77
    v_dot2c_f32_bf16 v161, s29, v81
    v_dot2c_f32_bf16 v160, s29, v78
    v_dot2c_f32_bf16 v161, s29, v82
    v_dot2c_f32_bf16 v160, s29, v79
    v_dot2c_f32_bf16 v161, s29, v83
    ds_read_b128 v[72:75], v179 offset:16384
    ds_read_b64_tr_b16 v[76:77], v155 offset:0
    ds_read_b64_tr_b16 v[78:79], v155 offset:512
    ds_read_b64_tr_b16 v[80:81], v159 offset:0
    ds_read_b64_tr_b16 v[82:83], v159 offset:512
    s_waitcnt lgkmcnt(10)
    v_mfma_f32_32x32x16_bf16 v[16:31], v[48:51], v[52:55], v[16:31]
    v_mfma_f32_32x32x16_bf16 v[32:47], v[48:51], v[56:59], v[32:47]
    s_waitcnt vmcnt(1)
    s_barrier
    ds_read_b128 v[48:51], v176 offset:32768
    ds_read_b64_tr_b16 v[52:53], v152 offset:8192
    ds_read_b64_tr_b16 v[54:55], v152 offset:8704
    ds_read_b64_tr_b16 v[56:57], v156 offset:8192
    ds_read_b64_tr_b16 v[58:59], v156 offset:8704
    s_waitcnt lgkmcnt(10)
    v_mfma_f32_32x32x16_bf16 v[16:31], v[60:63], v[64:67], v[16:31]
    v_mfma_f32_32x32x16_bf16 v[32:47], v[60:63], v[68:71], v[32:47]
    ds_read_b128 v[60:63], v177 offset:32768
    ds_read_b64_tr_b16 v[64:65], v153 offset:8192
    ds_read_b64_tr_b16 v[66:67], v153 offset:8704
    ds_read_b64_tr_b16 v[68:69], v157 offset:8192
    ds_read_b64_tr_b16 v[70:71], v157 offset:8704
    s_waitcnt lgkmcnt(10)
    v_mfma_f32_32x32x16_bf16 v[16:31], v[72:75], v[76:79], v[16:31]
    v_mfma_f32_32x32x16_bf16 v[32:47], v[72:75], v[80:83], v[32:47]
    ds_read_b128 v[72:75], v178 offset:32768
    ds_read_b64_tr_b16 v[76:77], v154 offset:8192
    ds_read_b64_tr_b16 v[78:79], v154 offset:8704
    ds_read_b64_tr_b16 v[80:81], v158 offset:8192
    ds_read_b64_tr_b16 v[82:83], v158 offset:8704
    s_waitcnt lgkmcnt(10)
    v_mfma_f32_32x32x16_bf16 v[16:31], v[48:51], v[52:55], v[16:31]
    v_mfma_f32_32x32x16_bf16 v[32:47], v[48:51], v[56:59], v[32:47]
    v_dot2c_f32_bf16 v160, s29, v52
    v_dot2c_f32_bf16 v161, s29, v56
    v_dot2c_f32_bf16 v160, s29, v53
    v_dot2c_f32_bf16 v161, s29, v57
    v_dot2c_f32_bf16 v160, s29, v54
    v_dot2c_f32_bf16 v161, s29, v58
    v_dot2c_f32_bf16 v160, s29, v55
    v_dot2c_f32_bf16 v161, s29, v59
    ds_read_b128 v[48:51], v179 offset:32768
    ds_read_b64_tr_b16 v[52:53], v155 offset:8192
    ds_read_b64_tr_b16 v[54:55], v155 offset:8704
    ds_read_b64_tr_b16 v[56:57], v159 offset:8192
    ds_read_b64_tr_b16 v[58:59], v159 offset:8704
    s_waitcnt lgkmcnt(10)
    v_mfma_f32_32x32x16_bf16 v[16:31], v[60:63], v[64:67], v[16:31]
    v_mfma_f32_32x32x16_bf16 v[32:47], v[60:63], v[68:71], v[32:47]
    ds_write_b64 v12, v[160:161]
    s_mov_b64 exec, 1
    ds_add_u32 v6, v7 offset:0
    s_mov_b64 exec, -1
    s_waitcnt lgkmcnt(5)
    v_mfma_f32_32x32x16_bf16 v[16:31], v[72:75], v[76:79], v[16:31]
    v_mfma_f32_32x32x16_bf16 v[32:47], v[72:75], v[80:83], v[32:47]
    ds_read_b64 v[100:101], v10
    ds_read_b128 v[84:87], v11 offset:0
    ds_read_b128 v[88:91], v11 offset:32
    ds_read_b128 v[92:95], v11 offset:64
    ds_read_b128 v[96:99], v11 offset:96
    v_and_b32 v10, 63, v0
    v_lshlrev_b32 v4, 2, v10
    v_lshlrev_b32 v10, 4, v10
    v_lshl_add_u32 v10, v14, 12, v10
    v_lshl_add_u32 v4, v14, 10, v4
    v_add_u32 v3, 32768, v4
    s_lshl_b32 s26, s22, 12
    s_waitcnt lgkmcnt(0)
    v_mfma_f32_32x32x16_bf16 v[16:31], v[48:51], v[52:55], v[16:31]
    v_mfma_f32_32x32x16_bf16 v[32:47], v[48:51], v[56:59], v[32:47]
    s_setprio 0
Lka_w0:
    ds_read_b32 v144, v6 offset:0
    s_waitcnt lgkmcnt(0)
    v_cmp_gt_u32 vcc, 4, v144
    s_cbranch_vccnz Lka_w0
    ds_read2st64_b64 v[112:115], v13 offset0:0 offset1:1
    ds_read2st64_b64 v[116:119], v13 offset0:2 offset1:3
    s_waitcnt lgkmcnt(0)
    v_add_f32 v112, v112, v114
    v_add_f32 v113, v113, v115
    v_add_f32 v116, v116, v118
    v_add_f32 v117, v117, v119
    v_add_f32 v160, v112, v116
    v_add_f32 v162, v113, v117
    v_cvt_pk_bf16_f32 v105, v160, 0
    v_mov_b32 v106, 0
    v_lshlrev_b32 v144, 16, v105
    v_sub_f32 v144, v160, v144
    v_mov_b32 v107, 0
    v_cvt_pk_bf16_f32 v104, v160, v144
    s_nop 1
    v_mfma_f32_32x32x16_bf16 v[16:31], v[100:103], v[104:107], v[16:31]
    v_cvt_pk_bf16_f32 v109, v162, 0
    v_mov_b32 v110, 0
    v_lshlrev_b32 v145, 16, v109
    v_sub_f32 v145, v162, v145
    v_mov_b32 v111, 0
    v_cvt_pk_bf16_f32 v108, v162, v145
    s_nop 1
    v_mfma_f32_32x32x16_bf16 v[32:47], v[100:103], v[108:111], v[32:47]
    s_nop 2
    v_fma_f32 v16, v16, v84, s28
    v_exp_f32 v144, v16 clamp
    v_max_f32 v16, s28, v16
    v_fma_f32 v16, v16, s30, v144
    v_fma_f32 v17, v17, v85, s28
    v_exp_f32 v145, v17 clamp
    v_max_f32 v17, s28, v17
    v_fma_f32 v17, v17, s30, v145
    v_cvt_pk_bf16_f32 v112, v16, v17
    v_fma_f32 v18, v18, v86, s28
    v_exp_f32 v144, v18 clamp
    v_max_f32 v18, s28, v18
    v_fma_f32 v18, v18, s30, v144
    v_fma_f32 v19, v19, v87, s28
    v_exp_f32 v145, v19 clamp
    v_max_f32 v19, s28, v19
    v_fma_f32 v19, v19, s30, v145
    v_cvt_pk_bf16_f32 v113, v18, v19
    v_fma_f32 v20, v20, v88, s28
    v_exp_f32 v144, v20 clamp
    v_max_f32 v20, s28, v20
    v_fma_f32 v20, v20, s30, v144
    v_fma_f32 v21, v21, v89, s28
    v_exp_f32 v145, v21 clamp
    v_max_f32 v21, s28, v21
    v_fma_f32 v21, v21, s30, v145
    v_cvt_pk_bf16_f32 v114, v20, v21
    v_fma_f32 v22, v22, v90, s28
    v_exp_f32 v144, v22 clamp
    v_max_f32 v22, s28, v22
    v_fma_f32 v22, v22, s30, v144
    v_fma_f32 v23, v23, v91, s28
    v_exp_f32 v145, v23 clamp
    v_max_f32 v23, s28, v23
    v_fma_f32 v23, v23, s30, v145
    v_cvt_pk_bf16_f32 v115, v22, v23
    v_pk_mul_f32 v[32:33], v[32:33], v[84:85]
    v_cvt_pk_bf16_f32 v120, v32, v33
    v_pk_mul_f32 v[34:35], v[34:35], v[86:87]
    v_cvt_pk_bf16_f32 v121, v34, v35
    v_pk_mul_f32 v[36:37], v[36:37], v[88:89]
    v_cvt_pk_bf16_f32 v122, v36, v37
    v_pk_mul_f32 v[38:39], v[38:39], v[90:91]
    v_cvt_pk_bf16_f32 v123, v38, v39
    s_mov_b32 exec_lo, 0x10000000
    s_mov_b32 exec_hi, 0x10000000
    v_mov_b32 v120, s29
    v_mov_b32 v121, s29
    v_mov_b32 v122, s29
    v_mov_b32 v123, s29
    s_mov_b64 exec, -1
    s_nop 0
    v_mfma_f32_32x32x16_bf16 v[128:143], v[112:115], v[120:123], 0
    v_fma_f32 v24, v24, v92, s28
    v_exp_f32 v144, v24 clamp
    v_max_f32 v24, s28, v24
    v_fma_f32 v24, v24, s30, v144
    v_fma_f32 v25, v25, v93, s28
    v_exp_f32 v145, v25 clamp
    v_max_f32 v25, s28, v25
    v_fma_f32 v25, v25, s30, v145
    v_cvt_pk_bf16_f32 v116, v24, v25
    v_fma_f32 v26, v26, v94, s28
    v_exp_f32 v144, v26 clamp
    v_max_f32 v26, s28, v26
    v_fma_f32 v26, v26, s30, v144
    v_fma_f32 v27, v27, v95, s28
    v_exp_f32 v145, v27 clamp
    v_max_f32 v27, s28, v27
    v_fma_f32 v27, v27, s30, v145
    v_cvt_pk_bf16_f32 v117, v26, v27
    v_fma_f32 v28, v28, v96, s28
    v_exp_f32 v144, v28 clamp
    v_max_f32 v28, s28, v28
    v_fma_f32 v28, v28, s30, v144
    v_fma_f32 v29, v29, v97, s28
    v_exp_f32 v145, v29 clamp
    v_max_f32 v29, s28, v29
    v_fma_f32 v29, v29, s30, v145
    v_cvt_pk_bf16_f32 v118, v28, v29
    v_fma_f32 v30, v30, v98, s28
    v_exp_f32 v144, v30 clamp
    v_max_f32 v30, s28, v30
    v_fma_f32 v30, v30, s30, v144
    v_fma_f32 v31, v31, v99, s28
    v_exp_f32 v145, v31 clamp
    v_max_f32 v31, s28, v31
    v_fma_f32 v31, v31, s30, v145
    v_cvt_pk_bf16_f32 v119, v30, v31
    v_pk_mul_f32 v[40:41], v[40:41], v[92:93]
    v_cvt_pk_bf16_f32 v124, v40, v41
    v_pk_mul_f32 v[42:43], v[42:43], v[94:95]
    v_cvt_pk_bf16_f32 v125, v42, v43
    v_pk_mul_f32 v[44:45], v[44:45], v[96:97]
    v_cvt_pk_bf16_f32 v126, v44, v45
    v_pk_mul_f32 v[46:47], v[46:47], v[98:99]
    v_cvt_pk_bf16_f32 v127, v46, v47
    s_mov_b32 exec_lo, 0x10000000
    s_mov_b32 exec_hi, 0x10000000
    v_mov_b32 v124, s29
    v_mov_b32 v125, s29
    v_mov_b32 v126, s29
    v_mov_b32 v127, s29
    s_mov_b64 exec, -1
    s_nop 0
    v_mfma_f32_32x32x16_bf16 v[128:143], v[116:119], v[124:127], v[128:143]
    s_waitcnt vmcnt(0)
    s_mov_b32 s31, 0x100000
Lka_poll:
    v_cmp_eq_u32 vcc, 0, v148
    s_cbranch_vccz Lka_pollok
    s_sleep 16
    buffer_load_dword v148, v5, s[16:19], s27 offen sc1
    s_waitcnt vmcnt(0)
    s_sub_u32 s31, s31, 1
    s_cbranch_scc0 Lka_poll
Lka_pollok:
    s_nop 8
    ds_write_b128 v10, v[128:131] offset:32768
    ds_write_b128 v10, v[132:135] offset:33792
    ds_write_b128 v10, v[136:139] offset:34816
    ds_write_b128 v10, v[140:143] offset:35840
    s_mov_b64 exec, 1
    ds_add_u32 v6, v7 offset:4
    s_mov_b64 exec, -1
Lka_w1:
    ds_read_b32 v144, v6 offset:4
    s_waitcnt lgkmcnt(0)
    v_cmp_gt_u32 vcc, 4, v144
    s_cbranch_vccnz Lka_w1
    ds_read2st64_b32 v[16:17], v3 offset0:0 offset1:16
    ds_read2st64_b32 v[18:19], v3 offset0:32 offset1:48
    ds_read2st64_b32 v[20:21], v3 offset0:1 offset1:17
    ds_read2st64_b32 v[22:23], v3 offset0:33 offset1:49
    ds_read2st64_b32 v[24:25], v3 offset0:2 offset1:18
    ds_read2st64_b32 v[26:27], v3 offset0:34 offset1:50
    ds_read2st64_b32 v[28:29], v3 offset0:3 offset1:19
    ds_read2st64_b32 v[30:31], v3 offset0:35 offset1:51
    s_waitcnt lgkmcnt(6)
    v_add_f32 v16, v16, v17
    v_add_f32 v18, v18, v19
    v_add_f32 v16, v16, v18
    buffer_atomic_add_f32 v16, v4, s[12:15], s26 offen offset:0
    s_waitcnt lgkmcnt(4)
    v_add_f32 v20, v20, v21
    v_add_f32 v22, v22, v23
    v_add_f32 v20, v20, v22
    buffer_atomic_add_f32 v20, v4, s[12:15], s26 offen offset:256
    s_waitcnt lgkmcnt(2)
    v_add_f32 v24, v24, v25
    v_add_f32 v26, v26, v27
    v_add_f32 v24, v24, v26
    s_cmp_eq_u32 s20, 3
    s_cbranch_scc1 Lka_kvend
    buffer_atomic_add_f32 v24, v4, s[12:15], s26 offen offset:512
    s_waitcnt lgkmcnt(0)
    v_add_f32 v28, v28, v29
    v_add_f32 v30, v30, v31
    v_add_f32 v28, v28, v30
    buffer_atomic_add_f32 v28, v4, s[12:15], s26 offen offset:768
Lka_kvend:
    s_mov_b64 exec, 1
    s_waitcnt vmcnt(0)
    ds_add_rtn_u32 v10, v6, v7 offset:16
    s_waitcnt lgkmcnt(0)
    v_cmp_ne_u32 vcc, 3, v10
    s_cbranch_vccnz Lka_kvx
    s_mov_b64 exec, 0xff
    v_and_b32 v5, 63, v0
    v_lshlrev_b32 v5, 11, v5
    s_lshl_b32 s26, s22, 7
    s_add_u32 s26, s26, 11681792
    buffer_atomic_add v7, v5, s[12:15], s26 offen sc1
Lka_kvx:
    s_mov_b64 exec, -1
    s_setprio 0
    s_branch Lkf_entry
Lka_q:
    v_bfe_u32 v11, v0, 2, 2
    v_lshl_add_u32 v10, v9, 3, v11
    v_lshlrev_b32 v10, 6, v10
    v_and_b32 v11, 1, v0
    v_bfe_u32 v12, v0, 4, 1
    v_lshl_add_u32 v11, v11, 1, v12
    v_bfe_u32 v12, v0, 1, 1
    v_lshl_add_u32 v11, v11, 1, v12
    s_and_b32 s26, s22, 1
    s_xor_b32 s26, s26, 1
    v_add_u32 v11, s26, v11
    v_and_b32 v11, 7, v11
    v_lshl_add_u32 v10, v11, 3, v10
    v_lshl_add_u32 v10, v14, 10, v10
    v_add_u32 v168, 0, v10
    v_xor_b32 v169, 0x400, v168
    v_xor_b32 v170, 0x800, v168
    v_xor_b32 v171, 0xc00, v168
    v_bfe_u32 v10, v0, 2, 6
    v_mul_u32_u24 v4, 2688, v10
    v_and_b32 v10, 3, v0
    v_lshl_add_u32 v4, v10, 4, v4
    v_mov_b32 v160, 0
    v_mov_b32 v161, 0
    v_mov_b32 v162, 0
    v_mov_b32 v163, 0
    v_mov_b32 v164, 0
    v_mov_b32 v165, 0
    s_waitcnt vmcnt(5)
    s_barrier
    ds_read_b128 v[16:19], v172 offset:0
    ds_read_b128 v[20:23], v173 offset:0
    ds_read_b128 v[24:27], v174 offset:0
    ds_read_b128 v[28:31], v175 offset:0
    s_lshl_b32 s26, s20, 11
    s_add_u32 m0, s26, 49152
    s_add_u32 s31, s31, 1
    s_cmp_eq_u32 s31, 7
    s_cselect_b32 s26, -6, 1
    s_lshl_b32 s26, s26, 7
    s_add_u32 s23, s23, s26
    buffer_load_dwordx4 v1, s[4:7], s23 offen lds
    buffer_load_dwordx4 v2, s[4:7], s23 offen offset:1024 lds
    s_lshl_b32 s26, s20, 10
    s_add_u32 m0, s26, 122880
    s_add_u32 s76, s76, 1
    s_cmp_eq_u32 s76, 7
    s_cselect_b32 s26, -6, 1
    s_mul_i32 s26, s26, 172032
    s_add_u32 s24, s24, s26
    buffer_load_dwordx4 v3, s[8:11], s24 offen lds
    s_cmp_lg_u32 s20, 7
    s_cbranch_scc1 Lka_noflag
    s_cmp_ge_u32 s78, 24
    s_cbranch_scc1 Lka_noflag
    s_lshl_b32 s26, s78, 2
    v_mov_b32 v5, 0
    s_mov_b64 exec, 1
    buffer_store_dword v7, v5, s[16:19], s26 offen sc1
    s_mov_b64 exec, -1
Lka_noflag:
    s_waitcnt lgkmcnt(3)
    v_dot2c_f32_bf16 v160, s29, v16
    v_dot2c_f32_bf16 v162, v16, v16
    v_dot2c_f32_bf16 v161, s29, v17
    v_dot2c_f32_bf16 v163, v17, v17
    v_dot2c_f32_bf16 v160, s29, v18
    v_dot2c_f32_bf16 v162, v18, v18
    v_dot2c_f32_bf16 v161, s29, v19
    v_dot2c_f32_bf16 v163, v19, v19
    s_waitcnt lgkmcnt(2)
    v_dot2c_f32_bf16 v160, s29, v20
    v_dot2c_f32_bf16 v162, v20, v20
    v_dot2c_f32_bf16 v161, s29, v21
    v_dot2c_f32_bf16 v163, v21, v21
    v_dot2c_f32_bf16 v160, s29, v22
    v_dot2c_f32_bf16 v162, v22, v22
    v_dot2c_f32_bf16 v161, s29, v23
    v_dot2c_f32_bf16 v163, v23, v23
    s_waitcnt lgkmcnt(1)
    v_dot2c_f32_bf16 v160, s29, v24
    v_dot2c_f32_bf16 v162, v24, v24
    v_dot2c_f32_bf16 v161, s29, v25
    v_dot2c_f32_bf16 v163, v25, v25
    v_dot2c_f32_bf16 v160, s29, v26
    v_dot2c_f32_bf16 v162, v26, v26
    v_dot2c_f32_bf16 v161, s29, v27
    v_dot2c_f32_bf16 v163, v27, v27
    s_waitcnt lgkmcnt(0)
    v_dot2c_f32_bf16 v160, s29, v28
    v_dot2c_f32_bf16 v162, v28, v28
    v_dot2c_f32_bf16 v161, s29, v29
    v_dot2c_f32_bf16 v163, v29, v29
    v_dot2c_f32_bf16 v160, s29, v30
    v_dot2c_f32_bf16 v162, v30, v30
    v_dot2c_f32_bf16 v161, s29, v31
    v_dot2c_f32_bf16 v163, v31, v31
    s_waitcnt vmcnt(6)
    s_barrier
    ds_read_b128 v[32:35], v172 offset:16384
    ds_read_b128 v[36:39], v173 offset:16384
    ds_read_b128 v[40:43], v174 offset:16384
    ds_read_b128 v[44:47], v175 offset:16384
    s_lshl_b32 s26, s20, 11
    s_add_u32 m0, s26, 65536
    s_add_u32 s31, s31, 1
    s_cmp_eq_u32 s31, 7
    s_cselect_b32 s26, -6, 1
    s_lshl_b32 s26, s26, 7
    s_add_u32 s23, s23, s26
    buffer_load_dwordx4 v1, s[4:7], s23 offen lds
    buffer_load_dwordx4 v2, s[4:7], s23 offen offset:1024 lds
    s_lshl_b32 s26, s20, 10
    s_add_u32 m0, s26, 131072
    s_add_u32 s76, s76, 1
    s_cmp_eq_u32 s76, 7
    s_cselect_b32 s26, -6, 1
    s_mul_i32 s26, s26, 172032
    s_add_u32 s24, s24, s26
    buffer_load_dwordx4 v3, s[8:11], s24 offen lds
    s_cmp_ge_u32 s20, 6
    s_cbranch_scc1 Lka_nopf
    s_lshr_b32 s26, s2, 3
    s_lshl_b32 s26, s26, 1
    s_add_u32 s26, s26, s20
    s_sub_u32 s26, s26, 4
    s_mul_i32 s26, s26, 49
    v_and_b32 v5, 63, v0
    v_min_u32 v5, 48, v5
    v_add_lshl_u32 v5, v5, s26, 7
    buffer_load_dword v190, v5, s[32:35], 0 offen
Lka_nopf:
    s_waitcnt lgkmcnt(3)
    v_dot2c_f32_bf16 v160, s29, v32
    v_dot2c_f32_bf16 v162, v32, v32
    v_dot2c_f32_bf16 v161, s29, v33
    v_dot2c_f32_bf16 v163, v33, v33
    v_dot2c_f32_bf16 v160, s29, v34
    v_dot2c_f32_bf16 v162, v34, v34
    v_dot2c_f32_bf16 v161, s29, v35
    v_dot2c_f32_bf16 v163, v35, v35
    s_waitcnt lgkmcnt(2)
    v_dot2c_f32_bf16 v160, s29, v36
    v_dot2c_f32_bf16 v162, v36, v36
    v_dot2c_f32_bf16 v161, s29, v37
    v_dot2c_f32_bf16 v163, v37, v37
    v_dot2c_f32_bf16 v160, s29, v38
    v_dot2c_f32_bf16 v162, v38, v38
    v_dot2c_f32_bf16 v161, s29, v39
    v_dot2c_f32_bf16 v163, v39, v39
    s_waitcnt lgkmcnt(1)
    v_dot2c_f32_bf16 v160, s29, v40
    v_dot2c_f32_bf16 v162, v40, v40
    v_dot2c_f32_bf16 v161, s29, v41
    v_dot2c_f32_bf16 v163, v41, v41
    v_dot2c_f32_bf16 v160, s29, v42
    v_dot2c_f32_bf16 v162, v42, v42
    v_dot2c_f32_bf16 v161, s29, v43
    v_dot2c_f32_bf16 v163, v43, v43
    s_waitcnt lgkmcnt(0)
    v_dot2c_f32_bf16 v160, s29, v44
    v_dot2c_f32_bf16 v162, v44, v44
    v_dot2c_f32_bf16 v161, s29, v45
    v_dot2c_f32_bf16 v163, v45, v45
    v_dot2c_f32_bf16 v160, s29, v46
    v_dot2c_f32_bf16 v162, v46, v46
    v_dot2c_f32_bf16 v161, s29, v47
    v_dot2c_f32_bf16 v163, v47, v47
    s_waitcnt vmcnt(6)
    s_barrier
    ds_read_b128 v[48:51], v172 offset:32768
    ds_read_b128 v[52:55], v173 offset:32768
    ds_read_b128 v[56:59], v174 offset:32768
    ds_read_b128 v[60:63], v175 offset:32768
    s_lshl_b32 s26, s20, 11
    s_add_u32 m0, s26, 81920
    s_add_u32 s31, s31, 1
    s_cmp_eq_u32 s31, 7
    s_cselect_b32 s26, -6, 1
    s_lshl_b32 s26, s26, 7
    s_add_u32 s23, s23, s26
    buffer_load_dwordx4 v1, s[4:7], s23 offen lds
    buffer_load_dwordx4 v2, s[4:7], s23 offen offset:1024 lds
    s_lshl_b32 s26, s20, 10
    s_add_u32 m0, s26, 139264
    s_add_u32 s76, s76, 1
    s_cmp_eq_u32 s76, 7
    s_cselect_b32 s26, -6, 1
    s_mul_i32 s26, s26, 172032
    s_add_u32 s24, s24, s26
    buffer_load_dwordx4 v3, s[8:11], s24 offen lds
    s_waitcnt lgkmcnt(3)
    v_dot2c_f32_bf16 v160, s29, v48
    v_dot2c_f32_bf16 v162, v48, v48
    v_dot2c_f32_bf16 v161, s29, v49
    v_dot2c_f32_bf16 v163, v49, v49
    v_dot2c_f32_bf16 v160, s29, v50
    v_dot2c_f32_bf16 v162, v50, v50
    v_dot2c_f32_bf16 v161, s29, v51
    v_dot2c_f32_bf16 v163, v51, v51
    s_waitcnt lgkmcnt(2)
    v_dot2c_f32_bf16 v160, s29, v52
    v_dot2c_f32_bf16 v162, v52, v52
    v_dot2c_f32_bf16 v161, s29, v53
    v_dot2c_f32_bf16 v163, v53, v53
    v_dot2c_f32_bf16 v160, s29, v54
    v_dot2c_f32_bf16 v162, v54, v54
    v_dot2c_f32_bf16 v161, s29, v55
    v_dot2c_f32_bf16 v163, v55, v55
    s_waitcnt lgkmcnt(1)
    v_dot2c_f32_bf16 v160, s29, v56
    v_dot2c_f32_bf16 v162, v56, v56
    v_dot2c_f32_bf16 v161, s29, v57
    v_dot2c_f32_bf16 v163, v57, v57
    v_dot2c_f32_bf16 v160, s29, v58
    v_dot2c_f32_bf16 v162, v58, v58
    v_dot2c_f32_bf16 v161, s29, v59
    v_dot2c_f32_bf16 v163, v59, v59
    s_waitcnt lgkmcnt(0)
    v_dot2c_f32_bf16 v160, s29, v60
    v_dot2c_f32_bf16 v162, v60, v60
    v_dot2c_f32_bf16 v161, s29, v61
    v_dot2c_f32_bf16 v163, v61, v61
    v_dot2c_f32_bf16 v160, s29, v62
    v_dot2c_f32_bf16 v162, v62, v62
    v_dot2c_f32_bf16 v161, s29, v63
    v_dot2c_f32_bf16 v163, v63, v63
    s_waitcnt vmcnt(6)
    s_barrier
    ds_read_b128 v[64:67], v172 offset:49152
    ds_read_b128 v[68:71], v173 offset:49152
    ds_read_b128 v[72:75], v174 offset:49152
    ds_read_b128 v[76:79], v175 offset:49152
    s_lshl_b32 s26, s20, 11
    s_add_u32 m0, s26, 98304
    s_add_u32 s31, s31, 1
    s_cmp_eq_u32 s31, 7
    s_cselect_b32 s26, -6, 1
    s_lshl_b32 s26, s26, 7
    s_add_u32 s23, s23, s26
    buffer_load_dwordx4 v1, s[4:7], s23 offen lds
    buffer_load_dwordx4 v2, s[4:7], s23 offen offset:1024 lds
    s_lshl_b32 s26, s20, 10
    s_add_u32 m0, s26, 147456
    s_add_u32 s76, s76, 1
    s_cmp_eq_u32 s76, 7
    s_cselect_b32 s26, -6, 1
    s_mul_i32 s26, s26, 172032
    s_add_u32 s24, s24, s26
    buffer_load_dwordx4 v3, s[8:11], s24 offen lds
    s_waitcnt lgkmcnt(3)
    v_dot2c_f32_bf16 v160, s29, v64
    v_dot2c_f32_bf16 v162, v64, v64
    v_dot2c_f32_bf16 v161, s29, v65
    v_dot2c_f32_bf16 v163, v65, v65
    v_dot2c_f32_bf16 v160, s29, v66
    v_dot2c_f32_bf16 v162, v66, v66
    v_dot2c_f32_bf16 v161, s29, v67
    v_dot2c_f32_bf16 v163, v67, v67
    s_waitcnt lgkmcnt(2)
    v_dot2c_f32_bf16 v160, s29, v68
    v_dot2c_f32_bf16 v162, v68, v68
    v_dot2c_f32_bf16 v161, s29, v69
    v_dot2c_f32_bf16 v163, v69, v69
    v_dot2c_f32_bf16 v160, s29, v70
    v_dot2c_f32_bf16 v162, v70, v70
    v_dot2c_f32_bf16 v161, s29, v71
    v_dot2c_f32_bf16 v163, v71, v71
    s_waitcnt lgkmcnt(1)
    v_dot2c_f32_bf16 v160, s29, v72
    v_dot2c_f32_bf16 v162, v72, v72
    v_dot2c_f32_bf16 v161, s29, v73
    v_dot2c_f32_bf16 v163, v73, v73
    v_dot2c_f32_bf16 v160, s29, v74
    v_dot2c_f32_bf16 v162, v74, v74
    v_dot2c_f32_bf16 v161, s29, v75
    v_dot2c_f32_bf16 v163, v75, v75
    s_waitcnt lgkmcnt(0)
    v_dot2c_f32_bf16 v160, s29, v76
    v_dot2c_f32_bf16 v162, v76, v76
    v_dot2c_f32_bf16 v161, s29, v77
    v_dot2c_f32_bf16 v163, v77, v77
    v_dot2c_f32_bf16 v160, s29, v78
    v_dot2c_f32_bf16 v162, v78, v78
    v_dot2c_f32_bf16 v161, s29, v79
    v_dot2c_f32_bf16 v163, v79, v79
    s_waitcnt vmcnt(6)
    s_barrier
    ds_read_b128 v[80:83], v176 offset:0
    ds_read_b128 v[84:87], v177 offset:0
    ds_read_b128 v[88:91], v178 offset:0
    ds_read_b128 v[92:95], v179 offset:0
    s_lshl_b32 s26, s20, 10
    s_add_u32 m0, s26, 114688
    s_add_u32 s76, s76, 1
    s_cmp_eq_u32 s76, 7
    s_cselect_b32 s26, -6, 1
    s_mul_i32 s26, s26, 172032
    s_add_u32 s24, s24, s26
    buffer_load_dwordx4 v3, s[8:11], s24 offen lds
    s_waitcnt lgkmcnt(3)
    v_dot2c_f32_bf16 v160, s29, v80
    v_dot2c_f32_bf16 v162, v80, v80
    v_dot2c_f32_bf16 v161, s29, v81
    v_dot2c_f32_bf16 v163, v81, v81
    v_dot2c_f32_bf16 v160, s29, v82
    v_dot2c_f32_bf16 v162, v82, v82
    v_dot2c_f32_bf16 v161, s29, v83
    v_dot2c_f32_bf16 v163, v83, v83
    s_waitcnt lgkmcnt(2)
    v_dot2c_f32_bf16 v160, s29, v84
    v_dot2c_f32_bf16 v162, v84, v84
    v_dot2c_f32_bf16 v161, s29, v85
    v_dot2c_f32_bf16 v163, v85, v85
    v_dot2c_f32_bf16 v160, s29, v86
    v_dot2c_f32_bf16 v162, v86, v86
    v_dot2c_f32_bf16 v161, s29, v87
    v_dot2c_f32_bf16 v163, v87, v87
    s_waitcnt lgkmcnt(1)
    v_dot2c_f32_bf16 v160, s29, v88
    v_dot2c_f32_bf16 v162, v88, v88
    v_dot2c_f32_bf16 v161, s29, v89
    v_dot2c_f32_bf16 v163, v89, v89
    v_dot2c_f32_bf16 v160, s29, v90
    v_dot2c_f32_bf16 v162, v90, v90
    v_dot2c_f32_bf16 v161, s29, v91
    v_dot2c_f32_bf16 v163, v91, v91
    s_waitcnt lgkmcnt(0)
    v_dot2c_f32_bf16 v160, s29, v92
    v_dot2c_f32_bf16 v162, v92, v92
    v_dot2c_f32_bf16 v161, s29, v93
    v_dot2c_f32_bf16 v163, v93, v93
    v_dot2c_f32_bf16 v160, s29, v94
    v_dot2c_f32_bf16 v162, v94, v94
    v_dot2c_f32_bf16 v161, s29, v95
    v_dot2c_f32_bf16 v163, v95, v95
    s_waitcnt vmcnt(4)
    s_barrier
    ds_read_b128 v[96:99], v176 offset:16384
    ds_read_b128 v[100:103], v177 offset:16384
    ds_read_b128 v[104:107], v178 offset:16384
    ds_read_b128 v[108:111], v179 offset:16384
    s_lshl_b32 s26, s20, 10
    s_add_u32 m0, s26, 122880
    s_add_u32 s76, s76, 1
    s_cmp_eq_u32 s76, 7
    s_cselect_b32 s26, -6, 1
    s_mul_i32 s26, s26, 172032
    s_add_u32 s24, s24, s26
    buffer_load_dwordx4 v3, s[8:11], s24 offen lds
    s_waitcnt lgkmcnt(3)
    v_dot2c_f32_bf16 v160, s29, v96
    v_dot2c_f32_bf16 v162, v96, v96
    v_dot2c_f32_bf16 v161, s29, v97
    v_dot2c_f32_bf16 v163, v97, v97
    v_dot2c_f32_bf16 v160, s29, v98
    v_dot2c_f32_bf16 v162, v98, v98
    v_dot2c_f32_bf16 v161, s29, v99
    v_dot2c_f32_bf16 v163, v99, v99
    s_waitcnt lgkmcnt(2)
    v_dot2c_f32_bf16 v160, s29, v100
    v_dot2c_f32_bf16 v162, v100, v100
    v_dot2c_f32_bf16 v161, s29, v101
    v_dot2c_f32_bf16 v163, v101, v101
    v_dot2c_f32_bf16 v160, s29, v102
    v_dot2c_f32_bf16 v162, v102, v102
    v_dot2c_f32_bf16 v161, s29, v103
    v_dot2c_f32_bf16 v163, v103, v103
    s_waitcnt lgkmcnt(1)
    v_dot2c_f32_bf16 v160, s29, v104
    v_dot2c_f32_bf16 v162, v104, v104
    v_dot2c_f32_bf16 v161, s29, v105
    v_dot2c_f32_bf16 v163, v105, v105
    v_dot2c_f32_bf16 v160, s29, v106
    v_dot2c_f32_bf16 v162, v106, v106
    v_dot2c_f32_bf16 v161, s29, v107
    v_dot2c_f32_bf16 v163, v107, v107
    s_waitcnt lgkmcnt(0)
    v_dot2c_f32_bf16 v160, s29, v108
    v_dot2c_f32_bf16 v162, v108, v108
    v_dot2c_f32_bf16 v161, s29, v109
    v_dot2c_f32_bf16 v163, v109, v109
    v_dot2c_f32_bf16 v160, s29, v110
    v_dot2c_f32_bf16 v162, v110, v110
    v_dot2c_f32_bf16 v161, s29, v111
    v_dot2c_f32_bf16 v163, v111, v111
    s_waitcnt vmcnt(2)
    s_barrier
    ds_read_b128 v[112:115], v176 offset:32768
    ds_read_b128 v[116:119], v177 offset:32768
    ds_read_b128 v[120:123], v178 offset:32768
    ds_read_b128 v[124:127], v179 offset:32768
    v_min_u32 v5, 23, v8
    v_lshlrev_b32 v5, 2, v5
    buffer_load_dword v191, v5, s[16:19], 0 offen sc1
    s_lshl_b32 s26, s20, 10
    s_add_i32 m0, s26, -4096
    s_add_u32 s27, s77, 0
    s_cmp_ge_u32 s27, 7
    s_cselect_b32 s26, 7, 0
    s_sub_u32 s27, s27, s26
    s_mul_i32 s27, s27, 172032
    s_add_u32 s27, s27, s25
    buffer_load_dwordx4 v4, s[8:11], s27 offen lds
    s_lshl_b32 s26, s20, 10
    s_add_i32 m0, s26, 0
    s_add_u32 s27, s77, 1
    s_cmp_ge_u32 s27, 7
    s_cselect_b32 s26, 7, 0
    s_sub_u32 s27, s27, s26
    s_mul_i32 s27, s27, 172032
    s_add_u32 s27, s27, s25
    buffer_load_dwordx4 v4, s[8:11], s27 offen lds
    s_lshl_b32 s26, s20, 10
    s_add_i32 m0, s26, 4096
    s_add_u32 s27, s77, 2
    s_cmp_ge_u32 s27, 7
    s_cselect_b32 s26, 7, 0
    s_sub_u32 s27, s27, s26
    s_mul_i32 s27, s27, 172032
    s_add_u32 s27, s27, s25
    buffer_load_dwordx4 v4, s[8:11], s27 offen lds
    s_lshl_b32 s26, s20, 10
    s_add_i32 m0, s26, 8192
    s_add_u32 s27, s77, 3
    s_cmp_ge_u32 s27, 7
    s_cselect_b32 s26, 7, 0
    s_sub_u32 s27, s27, s26
    s_mul_i32 s27, s27, 172032
    s_add_u32 s27, s27, s25
    buffer_load_dwordx4 v4, s[8:11], s27 offen lds
    s_lshl_b32 s26, s20, 10
    s_add_i32 m0, s26, 12288
    s_add_u32 s27, s77, 4
    s_cmp_ge_u32 s27, 7
    s_cselect_b32 s26, 7, 0
    s_sub_u32 s27, s27, s26
    s_mul_i32 s27, s27, 172032
    s_add_u32 s27, s27, s25
    buffer_load_dwordx4 v4, s[8:11], s27 offen lds
    s_lshl_b32 s26, s20, 10
    s_add_i32 m0, s26, 16384
    s_add_u32 s27, s77, 5
    s_cmp_ge_u32 s27, 7
    s_cselect_b32 s26, 7, 0
    s_sub_u32 s27, s27, s26
    s_mul_i32 s27, s27, 172032
    s_add_u32 s27, s27, s25
    buffer_load_dwordx4 v4, s[8:11], s27 offen lds
    s_lshl_b32 s26, s20, 10
    s_add_i32 m0, s26, 20480
    s_add_u32 s27, s77, 6
    s_cmp_ge_u32 s27, 7
    s_cselect_b32 s26, 7, 0
    s_sub_u32 s27, s27, s26
    s_mul_i32 s27, s27, 172032
    s_add_u32 s27, s27, s25
    buffer_load_dwordx4 v4, s[8:11], s27 offen lds
    s_waitcnt lgkmcnt(3)
    v_dot2c_f32_bf16 v160, s29, v112
    v_dot2c_f32_bf16 v162, v112, v112
    v_dot2c_f32_bf16 v161, s29, v113
    v_dot2c_f32_bf16 v163, v113, v113
    v_dot2c_f32_bf16 v160, s29, v114
    v_dot2c_f32_bf16 v162, v114, v114
    v_dot2c_f32_bf16 v161, s29, v115
    v_dot2c_f32_bf16 v163, v115, v115
    s_waitcnt lgkmcnt(2)
    v_dot2c_f32_bf16 v160, s29, v116
    v_dot2c_f32_bf16 v162, v116, v116
    v_dot2c_f32_bf16 v161, s29, v117
    v_dot2c_f32_bf16 v163, v117, v117
    v_dot2c_f32_bf16 v160, s29, v118
    v_dot2c_f32_bf16 v162, v118, v118
    v_dot2c_f32_bf16 v161, s29, v119
    v_dot2c_f32_bf16 v163, v119, v119
    s_waitcnt lgkmcnt(1)
    v_dot2c_f32_bf16 v160, s29, v120
    v_dot2c_f32_bf16 v162, v120, v120
    v_dot2c_f32_bf16 v161, s29, v121
    v_dot2c_f32_bf16 v163, v121, v121
    v_dot2c_f32_bf16 v160, s29, v122
    v_dot2c_f32_bf16 v162, v122, v122
    v_dot2c_f32_bf16 v161, s29, v123
    v_dot2c_f32_bf16 v163, v123, v123
    s_waitcnt lgkmcnt(0)
    v_dot2c_f32_bf16 v160, s29, v124
    v_dot2c_f32_bf16 v162, v124, v124
    v_dot2c_f32_bf16 v161, s29, v125
    v_dot2c_f32_bf16 v163, v125, v125
    v_dot2c_f32_bf16 v160, s29, v126
    v_dot2c_f32_bf16 v162, v126, v126
    v_dot2c_f32_bf16 v161, s29, v127
    v_dot2c_f32_bf16 v163, v127, v127
    s_waitcnt vmcnt(9)
    s_barrier
    v_lshlrev_b32 v11, 2, v15
    v_lshlrev_b32 v10, 3, v15
    v_mov_b32 v183, 0
    v_add_f32 v160, v160, v161
    v_add_f32 v162, v162, v163
    v_mov_b32 v161, v160
    v_mov_b32 v163, v162
    v_add_u32 v10, 155648, v10
    v_add_u32 v11, 156672, v11
    v_permlane32_swap_b32 v160, v161
    v_permlane32_swap_b32 v162, v163
    v_mov_b32 v182, 0
    v_add_f32 v160, v160, v161
    v_add_f32 v162, v162, v163
    v_mul_f32 v160, 0xbb124925, v160
    v_mul_f32 v162, 0x3b124925, v162
    v_fma_f32 v162, -v160, v160, v162
    v_max_f32 v162, 0, v162
    v_add_f32 v162, 0x3727c5ac, v162
    v_rsq_f32 v166, v162
    v_cvt_pk_bf16_f32 v180, v160, v160
    v_and_b32 v188, 0xffff0000, v180
    v_sub_f32 v188, v160, v188
    v_cvt_pk_bf16_f32 v181, v188, 0
    v_mul_f32 v166, 0x3fb8aa3b, v166
    ds_write_b64 v10, v[180:181]
    ds_write_b32 v11, v166
    s_waitcnt lgkmcnt(0)
    v_lshlrev_b32 v12, 2, v0
    v_add_u32 v12, 158720, v12
    v_and_b32 v10, 63, v0
    v_lshlrev_b32 v13, 2, v10
    v_add_u32 v13, 159744, v13
    v_lshlrev_b32 v10, 4, v10
    s_lshl_b32 s26, s21, 2
    s_add_u32 s26, s26, s20
    s_sub_u32 s26, s26, 4
    s_lshl_b32 s26, s26, 4
    s_xor_b32 s27, s22, 1
    s_add_u32 s26, s26, s27
    s_lshl_b32 s26, s26, 11
    s_add_u32 s26, s26, 65536
    s_waitcnt vmcnt(8)
    s_barrier
    s_setprio 0
    s_waitcnt vmcnt(3)
    s_mov_b64 exec, 1
    ds_add_u32 v6, v7 offset:8
    s_mov_b64 exec, -1
Lka_wq0:
    ds_read_b32 v188, v6 offset:8
    s_waitcnt lgkmcnt(0)
    v_cmp_gt_u32 vcc, 4, v188
    s_cbranch_vccnz Lka_wq0
    ds_read_b64_tr_b16 v[144:145], v168 offset:0
    ds_read_b64_tr_b16 v[146:147], v168 offset:256
    ds_read_b64_tr_b16 v[148:149], v169 offset:0
    ds_read_b64_tr_b16 v[150:151], v169 offset:256
    ds_read_b64_tr_b16 v[152:153], v170 offset:0
    ds_read_b64_tr_b16 v[154:155], v170 offset:256
    ds_read_b64_tr_b16 v[156:157], v171 offset:0
    ds_read_b64_tr_b16 v[158:159], v171 offset:256
    s_waitcnt lgkmcnt(6)
    v_mfma_f32_32x32x16_bf16 v[128:143], v[144:147], v[16:19], 0
    v_dot2c_f32_bf16 v164, s29, v144
    v_dot2c_f32_bf16 v165, s29, v145
    v_dot2c_f32_bf16 v164, s29, v146
    v_dot2c_f32_bf16 v165, s29, v147
    ds_read_b64_tr_b16 v[144:145], v168 offset:4096
    ds_read_b64_tr_b16 v[146:147], v168 offset:4352
    s_waitcnt lgkmcnt(6)
    v_mfma_f32_32x32x16_bf16 v[128:143], v[148:151], v[20:23], v[128:143]
    ds_read_b64_tr_b16 v[148:149], v169 offset:4096
    ds_read_b64_tr_b16 v[150:151], v169 offset:4352
    s_waitcnt lgkmcnt(6)
    v_mfma_f32_32x32x16_bf16 v[128:143], v[152:155], v[24:27], v[128:143]
    ds_read_b64_tr_b16 v[152:153], v170 offset:4096
    ds_read_b64_tr_b16 v[154:155], v170 offset:4352
    s_waitcnt lgkmcnt(6)
    v_mfma_f32_32x32x16_bf16 v[128:143], v[156:159], v[28:31], v[128:143]
    ds_read_b64_tr_b16 v[156:157], v171 offset:4096
    ds_read_b64_tr_b16 v[158:159], v171 offset:4352
    s_waitcnt lgkmcnt(6)
    v_mfma_f32_32x32x16_bf16 v[128:143], v[144:147], v[32:35], v[128:143]
    v_dot2c_f32_bf16 v164, s29, v144
    v_dot2c_f32_bf16 v165, s29, v145
    v_dot2c_f32_bf16 v164, s29, v146
    v_dot2c_f32_bf16 v165, s29, v147
    ds_read_b64_tr_b16 v[144:145], v168 offset:8192
    ds_read_b64_tr_b16 v[146:147], v168 offset:8448
    s_waitcnt lgkmcnt(6)
    v_mfma_f32_32x32x16_bf16 v[128:143], v[148:151], v[36:39], v[128:143]
    ds_read_b64_tr_b16 v[148:149], v169 offset:8192
    ds_read_b64_tr_b16 v[150:151], v169 offset:8448
    s_waitcnt lgkmcnt(6)
    v_mfma_f32_32x32x16_bf16 v[128:143], v[152:155], v[40:43], v[128:143]
    ds_read_b64_tr_b16 v[152:153], v170 offset:8192
    ds_read_b64_tr_b16 v[154:155], v170 offset:8448
    s_waitcnt lgkmcnt(6)
    v_mfma_f32_32x32x16_bf16 v[128:143], v[156:159], v[44:47], v[128:143]
    ds_read_b64_tr_b16 v[156:157], v171 offset:8192
    ds_read_b64_tr_b16 v[158:159], v171 offset:8448
    s_waitcnt lgkmcnt(6)
    v_mfma_f32_32x32x16_bf16 v[128:143], v[144:147], v[48:51], v[128:143]
    v_dot2c_f32_bf16 v164, s29, v144
    v_dot2c_f32_bf16 v165, s29, v145
    v_dot2c_f32_bf16 v164, s29, v146
    v_dot2c_f32_bf16 v165, s29, v147
    ds_read_b64_tr_b16 v[144:145], v168 offset:12288
    ds_read_b64_tr_b16 v[146:147], v168 offset:12544
    s_waitcnt lgkmcnt(6)
    v_mfma_f32_32x32x16_bf16 v[128:143], v[148:151], v[52:55], v[128:143]
    ds_read_b64_tr_b16 v[148:149], v169 offset:12288
    ds_read_b64_tr_b16 v[150:151], v169 offset:12544
    s_waitcnt lgkmcnt(6)
    v_mfma_f32_32x32x16_bf16 v[128:143], v[152:155], v[56:59], v[128:143]
    ds_read_b64_tr_b16 v[152:153], v170 offset:12288
    ds_read_b64_tr_b16 v[154:155], v170 offset:12544
    s_waitcnt lgkmcnt(6)
    v_mfma_f32_32x32x16_bf16 v[128:143], v[156:159], v[60:63], v[128:143]
    ds_read_b64_tr_b16 v[156:157], v171 offset:12288
    ds_read_b64_tr_b16 v[158:159], v171 offset:12544
    s_waitcnt lgkmcnt(6)
    v_mfma_f32_32x32x16_bf16 v[128:143], v[144:147], v[64:67], v[128:143]
    v_dot2c_f32_bf16 v164, s29, v144
    v_dot2c_f32_bf16 v165, s29, v145
    v_dot2c_f32_bf16 v164, s29, v146
    v_dot2c_f32_bf16 v165, s29, v147
    s_waitcnt lgkmcnt(4)
    v_mfma_f32_32x32x16_bf16 v[128:143], v[148:151], v[68:71], v[128:143]
    s_waitcnt lgkmcnt(2)
    v_mfma_f32_32x32x16_bf16 v[128:143], v[152:155], v[72:75], v[128:143]
    s_waitcnt lgkmcnt(0)
    v_mfma_f32_32x32x16_bf16 v[128:143], v[156:159], v[76:79], v[128:143]
    s_waitcnt vmcnt(0)
    s_mov_b64 exec, 1
    ds_add_u32 v6, v7 offset:8
    s_mov_b64 exec, -1
Lka_wq1:
    ds_read_b32 v188, v6 offset:8
    s_waitcnt lgkmcnt(0)
    v_cmp_gt_u32 vcc, 8, v188
    s_cbranch_vccnz Lka_wq1
    ds_read_b64_tr_b16 v[144:145], v168 offset:16384
    ds_read_b64_tr_b16 v[146:147], v168 offset:16640
    ds_read_b64_tr_b16 v[148:149], v169 offset:16384
    ds_read_b64_tr_b16 v[150:151], v169 offset:16640
    ds_read_b64_tr_b16 v[152:153], v170 offset:16384
    ds_read_b64_tr_b16 v[154:155], v170 offset:16640
    ds_read_b64_tr_b16 v[156:157], v171 offset:16384
    ds_read_b64_tr_b16 v[158:159], v171 offset:16640
    s_waitcnt lgkmcnt(6)
    v_mfma_f32_32x32x16_bf16 v[128:143], v[144:147], v[80:83], v[128:143]
    v_dot2c_f32_bf16 v164, s29, v144
    v_dot2c_f32_bf16 v165, s29, v145
    v_dot2c_f32_bf16 v164, s29, v146
    v_dot2c_f32_bf16 v165, s29, v147
    ds_read_b64_tr_b16 v[144:145], v168 offset:20480
    ds_read_b64_tr_b16 v[146:147], v168 offset:20736
    s_waitcnt lgkmcnt(6)
    v_mfma_f32_32x32x16_bf16 v[128:143], v[148:151], v[84:87], v[128:143]
    ds_read_b64_tr_b16 v[148:149], v169 offset:20480
    ds_read_b64_tr_b16 v[150:151], v169 offset:20736
    s_waitcnt lgkmcnt(6)
    v_mfma_f32_32x32x16_bf16 v[128:143], v[152:155], v[88:91], v[128:143]
    ds_read_b64_tr_b16 v[152:153], v170 offset:20480
    ds_read_b64_tr_b16 v[154:155], v170 offset:20736
    s_waitcnt lgkmcnt(6)
    v_mfma_f32_32x32x16_bf16 v[128:143], v[156:159], v[92:95], v[128:143]
    ds_read_b64_tr_b16 v[156:157], v171 offset:20480
    ds_read_b64_tr_b16 v[158:159], v171 offset:20736
    s_waitcnt lgkmcnt(6)
    v_mfma_f32_32x32x16_bf16 v[128:143], v[144:147], v[96:99], v[128:143]
    v_dot2c_f32_bf16 v164, s29, v144
    v_dot2c_f32_bf16 v165, s29, v145
    v_dot2c_f32_bf16 v164, s29, v146
    v_dot2c_f32_bf16 v165, s29, v147
    ds_read_b64_tr_b16 v[144:145], v168 offset:24576
    ds_read_b64_tr_b16 v[146:147], v168 offset:24832
    s_waitcnt lgkmcnt(6)
    v_mfma_f32_32x32x16_bf16 v[128:143], v[148:151], v[100:103], v[128:143]
    ds_read_b64_tr_b16 v[148:149], v169 offset:24576
    ds_read_b64_tr_b16 v[150:151], v169 offset:24832
    s_waitcnt lgkmcnt(6)
    v_mfma_f32_32x32x16_bf16 v[128:143], v[152:155], v[104:107], v[128:143]
    ds_read_b64_tr_b16 v[152:153], v170 offset:24576
    ds_read_b64_tr_b16 v[154:155], v170 offset:24832
    s_waitcnt lgkmcnt(6)
    v_mfma_f32_32x32x16_bf16 v[128:143], v[156:159], v[108:111], v[128:143]
    ds_read_b64_tr_b16 v[156:157], v171 offset:24576
    ds_read_b64_tr_b16 v[158:159], v171 offset:24832
    s_waitcnt lgkmcnt(6)
    v_mfma_f32_32x32x16_bf16 v[128:143], v[144:147], v[112:115], v[128:143]
    v_dot2c_f32_bf16 v164, s29, v144
    v_dot2c_f32_bf16 v165, s29, v145
    v_dot2c_f32_bf16 v164, s29, v146
    v_dot2c_f32_bf16 v165, s29, v147
    s_waitcnt lgkmcnt(4)
    v_mfma_f32_32x32x16_bf16 v[128:143], v[148:151], v[116:119], v[128:143]
    s_waitcnt lgkmcnt(2)
    v_mfma_f32_32x32x16_bf16 v[128:143], v[152:155], v[120:123], v[128:143]
    v_add_f32 v164, v164, v165
    ds_write_b32 v12, v164
    s_mov_b64 exec, 1
    ds_add_u32 v6, v7 offset:12
    s_mov_b64 exec, -1
    s_waitcnt lgkmcnt(0)
    v_mfma_f32_32x32x16_bf16 v[128:143], v[156:159], v[124:127], v[128:143]
Lka_w4:
    ds_read_b32 v188, v6 offset:12
    s_waitcnt lgkmcnt(0)
    v_cmp_gt_u32 vcc, 4, v188
    s_cbranch_vccnz Lka_w4
    ds_read2st64_b32 v[144:145], v13 offset0:0 offset1:1
    ds_read2st64_b32 v[146:147], v13 offset0:2 offset1:3
    s_waitcnt lgkmcnt(0)
    v_add_f32 v144, v144, v145
    v_add_f32 v146, v146, v147
    v_add_f32 v164, v144, v146
    v_cvt_pk_bf16_f32 v185, v164, 0
    v_mov_b32 v186, 0
    v_lshlrev_b32 v188, 16, v185
    v_sub_f32 v188, v164, v188
    v_mov_b32 v187, 0
    v_cvt_pk_bf16_f32 v184, v164, v188
    s_nop 1
    v_mfma_f32_32x32x16_bf16 v[128:143], v[184:187], v[180:183], v[128:143]
    s_nop 11
    v_fma_f32 v128, v128, v166, s28
    v_exp_f32 v188, v128 clamp
    v_max_f32 v128, s28, v128
    v_fma_f32 v128, v128, s30, v188
    v_fma_f32 v129, v129, v166, s28
    v_exp_f32 v189, v129 clamp
    v_max_f32 v129, s28, v129
    v_fma_f32 v129, v129, s30, v189
    v_cvt_pk_bf16_f32 v144, v128, v129
    v_fma_f32 v130, v130, v166, s28
    v_exp_f32 v188, v130 clamp
    v_max_f32 v130, s28, v130
    v_fma_f32 v130, v130, s30, v188
    v_fma_f32 v131, v131, v166, s28
    v_exp_f32 v189, v131 clamp
    v_max_f32 v131, s28, v131
    v_fma_f32 v131, v131, s30, v189
    v_cvt_pk_bf16_f32 v145, v130, v131
    v_fma_f32 v132, v132, v166, s28
    v_exp_f32 v188, v132 clamp
    v_max_f32 v132, s28, v132
    v_fma_f32 v132, v132, s30, v188
    v_fma_f32 v133, v133, v166, s28
    v_exp_f32 v189, v133 clamp
    v_max_f32 v133, s28, v133
    v_fma_f32 v133, v133, s30, v189
    v_cvt_pk_bf16_f32 v146, v132, v133
    v_fma_f32 v134, v134, v166, s28
    v_exp_f32 v188, v134 clamp
    v_max_f32 v134, s28, v134
    v_fma_f32 v134, v134, s30, v188
    v_fma_f32 v135, v135, v166, s28
    v_exp_f32 v189, v135 clamp
    v_max_f32 v135, s28, v135
    v_fma_f32 v135, v135, s30, v189
    v_cvt_pk_bf16_f32 v147, v134, v135
    buffer_store_dwordx4 v[144:147], v10, s[12:15], s26 offen sc1
    v_fma_f32 v136, v136, v166, s28
    v_exp_f32 v188, v136 clamp
    v_max_f32 v136, s28, v136
    v_fma_f32 v136, v136, s30, v188
    v_fma_f32 v137, v137, v166, s28
    v_exp_f32 v189, v137 clamp
    v_max_f32 v137, s28, v137
    v_fma_f32 v137, v137, s30, v189
    v_cvt_pk_bf16_f32 v148, v136, v137
    v_fma_f32 v138, v138, v166, s28
    v_exp_f32 v188, v138 clamp
    v_max_f32 v138, s28, v138
    v_fma_f32 v138, v138, s30, v188
    v_fma_f32 v139, v139, v166, s28
    v_exp_f32 v189, v139 clamp
    v_max_f32 v139, s28, v139
    v_fma_f32 v139, v139, s30, v189
    v_cvt_pk_bf16_f32 v149, v138, v139
    v_fma_f32 v140, v140, v166, s28
    v_exp_f32 v188, v140 clamp
    v_max_f32 v140, s28, v140
    v_fma_f32 v140, v140, s30, v188
    v_fma_f32 v141, v141, v166, s28
    v_exp_f32 v189, v141 clamp
    v_max_f32 v141, s28, v141
    v_fma_f32 v141, v141, s30, v189
    v_cvt_pk_bf16_f32 v150, v140, v141
    v_fma_f32 v142, v142, v166, s28
    v_exp_f32 v188, v142 clamp
    v_max_f32 v142, s28, v142
    v_fma_f32 v142, v142, s30, v188
    v_fma_f32 v143, v143, v166, s28
    v_exp_f32 v189, v143 clamp
    v_max_f32 v143, s28, v143
    v_fma_f32 v143, v143, s30, v189
    v_cvt_pk_bf16_f32 v151, v142, v143
    buffer_store_dwordx4 v[148:151], v10, s[12:15], s26 offen offset:1024 sc1
    s_mov_b32 s31, 0x100000
Lka_qpoll:
    v_cmp_eq_u32 vcc, 0, v191
    s_cbranch_vccz Lka_qpollok
    s_sleep 16
    buffer_load_dword v191, v5, s[16:19], 0 offen sc1
    s_waitcnt vmcnt(0)
    s_sub_u32 s31, s31, 1
    s_cbranch_scc0 Lka_qpoll
Lka_qpollok:
    s_mov_b64 exec, 1
    s_waitcnt vmcnt(0)
    ds_add_rtn_u32 v10, v6, v7 offset:20
    s_waitcnt lgkmcnt(0)
    v_cmp_ne_u32 vcc, 3, v10
    s_cbranch_vccnz Lka_qx
    s_mov_b64 exec, 0x3fff
    v_and_b32 v5, 63, v0
    v_lshlrev_b32 v5, 7, v5
    s_mul_i32 s26, s21, 1792
    s_add_u32 s26, s26, 11649024
    buffer_atomic_add v7, v5, s[12:15], s26 offen sc1
Lka_qx:
    s_mov_b64 exec, -1
    s_setprio 0
    s_branch Lkf_entry
Lka_end:
    s_endpgm
Lkf_entry:
    s_barrier
    s_cmp_ge_u32 s2, 224
    s_cbranch_scc1 Lkf_cs
    s_mov_b32 s8, s32
    s_mov_b32 s9, s33
    v_lshrrev_b32 v5, 6, v0
    v_and_b32 v1, 63, v0
    v_readfirstlane_b32 s20, v5
    v_lshlrev_b32 v1, 4, v1
    v_bfe_u32 v9, v0, 5, 1
    s_lshr_b32 s24, s2, 3
    s_mul_i32 s34, s24, 37
    s_lshr_b32 s34, s34, 8
    s_mul_i32 s22, s34, 7
    s_sub_u32 s22, s24, s22
    s_and_b32 s23, s2, 7
    s_lshl_b32 s23, s23, 2
    s_add_u32 s21, s34, s23
    s_lshl_b32 s30, s22, 7
    s_mov_b32 s14, 11730944
    s_mov_b32 s15, 0x20000
    s_cmp_ge_u32 s20, 4
    s_cbranch_scc1 Lkf_ld
    v_bfe_u32 v6, v0, 3, 2
    v_and_b32 v7, 3, v0
    v_lshl_add_u32 v6, v6, 2, v7
    v_bfe_u32 v7, v0, 2, 1
    v_mad_u32_u24 v7, v7, 14, v6
    v_cmp_gt_u32 vcc, 14, v6
    v_bfe_u32 v6, v0, 3, 3
    v_and_b32 v8, 7, v0
    v_cndmask_b32 v7, 28, v7, vcc
    v_lshlrev_b32 v2, 4, v7
    v_lshl_add_u32 v2, v9, 11, v2
    v_bfe_u32 v7, v0, 4, 1
    v_lshlrev_b32 v7, 2, v7
    v_xor_b32 v7, v7, v8
    v_mul_u32_u24 v3, 896, v6
    v_lshl_add_u32 v3, v7, 4, v3
    s_add_u32 s31, s34, s22
    s_and_b32 s31, s31, 3
    s_lshl_b32 s23, s20, 2
    s_add_u32 s31, s31, s23
    s_and_b32 s23, s20, 1
    s_lshl_b32 s24, s21, 1
    s_add_u32 s25, s24, s23
    s_lshl_b32 s29, s25, 15
    s_add_u32 s29, s29, 65536
    s_lshl_b32 s23, s20, 14
    s_add_u32 m0, s23, 98304
    s_mov_b32 s6, 1835008
    s_mov_b32 s7, 0x20000
    s_mov_b32 s10, 401408
    s_mov_b32 s11, 0x20000
    s_mov_b32 s26, 0x358637bd
    s_mov_b32 s27, 0x3f803f80
    s_mov_b32 s19, 0x3f317218
    s_waitcnt lgkmcnt(0)
    v_bfe_u32 v7, v0, 2, 2
    v_mad_u32_u24 v5, v9, 14, v7
    v_lshlrev_b32 v5, 7, v5
    v_lshrrev_b32 v7, 1, v7
    v_xor_b32 v7, v7, v9
    v_bfe_u32 v8, v0, 7, 1
    v_xor_b32 v7, v7, v8
    v_lshl_add_u32 v5, v7, 6, v5
    v_and_b32 v7, 1, v0
    v_lshl_add_u32 v5, v7, 5, v5
    v_bfe_u32 v7, v0, 4, 1
    v_lshl_add_u32 v5, v7, 4, v5
    v_bfe_u32 v7, v0, 1, 1
    v_lshl_add_u32 v5, v7, 3, v5
    v_lshrrev_b32 v7, 6, v0
    v_lshl_add_u32 v5, v7, 14, v5
    v_add_u32 v14, 98304, v5
    v_xor_b32 v15, 64, v14
    s_xor_b32 s23, s31, 0
    s_mul_i32 s23, s23, 25088
    s_add_u32 s23, s23, s30
    buffer_load_dwordx4 v3, s[8:11], s23 offen offset:0 lds
    s_add_u32 s23, s23, 6144
    buffer_load_dwordx4 v3, s[8:11], s23 offen offset:1024 lds
    s_add_u32 s23, s23, 6144
    buffer_load_dwordx4 v3, s[8:11], s23 offen offset:2048 lds
    s_add_u32 s23, s23, 6144
    buffer_load_dwordx4 v3, s[8:11], s23 offen offset:3072 lds
    s_add_u32 m0, m0, 4096
    s_xor_b32 s23, s31, 1
    s_mul_i32 s23, s23, 25088
    s_add_u32 s23, s23, s30
    buffer_load_dwordx4 v3, s[8:11], s23 offen offset:0 lds
    s_add_u32 s23, s23, 6144
    buffer_load_dwordx4 v3, s[8:11], s23 offen offset:1024 lds
    s_add_u32 s23, s23, 6144
    buffer_load_dwordx4 v3, s[8:11], s23 offen offset:2048 lds
    s_add_u32 s23, s23, 6144
    buffer_load_dwordx4 v3, s[8:11], s23 offen offset:3072 lds
    s_add_u32 m0, m0, 4096
    s_xor_b32 s23, s31, 2
    s_mul_i32 s23, s23, 25088
    s_add_u32 s23, s23, s30
    buffer_load_dwordx4 v3, s[8:11], s23 offen offset:0 lds
    s_add_u32 s23, s23, 6144
    buffer_load_dwordx4 v3, s[8:11], s23 offen offset:1024 lds
    s_add_u32 s23, s23, 6144
    buffer_load_dwordx4 v3, s[8:11], s23 offen offset:2048 lds
    s_add_u32 s23, s23, 6144
    buffer_load_dwordx4 v3, s[8:11], s23 offen offset:3072 lds
    s_add_u32 m0, m0, 4096
    s_xor_b32 s23, s31, 3
    s_mul_i32 s23, s23, 25088
    s_add_u32 s23, s23, s30
    buffer_load_dwordx4 v3, s[8:11], s23 offen offset:0 lds
    s_add_u32 s23, s23, 6144
    buffer_load_dwordx4 v3, s[8:11], s23 offen offset:1024 lds
    s_add_u32 s23, s23, 6144
    buffer_load_dwordx4 v3, s[8:11], s23 offen offset:2048 lds
    s_add_u32 s23, s23, 6144
    buffer_load_dwordx4 v3, s[8:11], s23 offen offset:3072 lds
    s_add_u32 m0, m0, 4096
    v_and_b32 v6, 31, v0
    v_mul_u32_u24 v4, 896, v6
    v_lshl_add_u32 v4, v9, 5, v4
    s_mul_i32 s23, s25, 28672
    s_add_u32 s23, s23, s30
    s_lshr_b32 s24, s20, 1
    s_lshl_b32 s24, s24, 6
    s_add_u32 s23, s23, s24
    buffer_load_dwordx4 v[248:251], v4, s[4:7], s23 offen
    buffer_load_dwordx4 v[252:255], v4, s[4:7], s23 offen offset:16
    s_mul_i32 s73, s21, 7
    s_add_u32 s73, s73, s22
    s_lshl_b32 s73, s73, 7
    s_add_u32 s73, s73, 11649024
    v_lshrrev_b32 v7, 6, v0
    v_add_u32 v6, 98304, v1
    v_lshl_add_u32 v8, v7, 14, v6
    v_xor_b32 v11, 1, v7
    v_lshl_add_u32 v11, v11, 14, v6
    v_xor_b32 v12, 2, v7
    v_lshl_add_u32 v12, v12, 14, v6
    v_xor_b32 v13, 3, v7
    v_lshl_add_u32 v13, v13, 14, v6
    s_lshl_b32 s23, s22, 1
    s_lshr_b32 s24, s20, 1
    s_add_u32 s23, s23, s24
    s_mul_i32 s24, s25, 14
    s_add_u32 s23, s23, s24
    s_lshl_b32 s75, s23, 8
    s_add_u32 s75, s75, 3997696
    s_lshl_b32 s74, s23, 11
    s_add_u32 s74, s74, 2162688
    s_cmp_lg_u32 s20, 0
    s_cbranch_scc1 Lkf_p0dr
    s_mov_b32 s72, 0x200000
    s_and_b32 s23, s2, 7
    s_lshl_b32 s23, s23, 11
    s_add_u32 s23, s23, 11681792
    s_sub_u32 s23, s23, s73
    v_cmp_gt_u32 vcc, 16, v0
    v_lshlrev_b32 v5, 7, v0
    v_add_u32 v5, s23, v5
    v_cndmask_b32 v5, 0, v5, vcc
Lkf_p0:
    buffer_load_dword v6, v5, s[12:15], s73 offen sc1
    s_waitcnt vmcnt(0)
    v_cmp_gt_u32 vcc, 16, v6
    s_cbranch_vccz Lkf_p0ok
    s_sleep 1
    s_sub_u32 s72, s72, 1
    s_cbranch_scc0 Lkf_p0
Lkf_p0dr:
    s_waitcnt vmcnt(0)
Lkf_p0ok:
    s_barrier
    s_xor_b32 s23, s31, 0
    s_lshl_b32 s28, s23, 12
    s_lshl_b32 s23, s23, 11
    s_add_u32 s23, s23, s29
    s_xor_b32 s24, s23, 0x8000
    buffer_load_dwordx4 v[16:19], v2, s[12:15], s28 offen offset:0 sc1
    buffer_load_dwordx4 v[20:23], v2, s[12:15], s28 offen offset:512 sc1
    buffer_load_dwordx4 v[24:27], v2, s[12:15], s28 offen offset:1024 sc1
    buffer_load_dwordx4 v[28:31], v2, s[12:15], s28 offen offset:1536 sc1
    buffer_load_dwordx4 v[80:83], v1, s[12:15], s23 offen offset:0 sc1
    buffer_load_dwordx4 v[84:87], v1, s[12:15], s23 offen offset:1024 sc1
    buffer_load_dwordx4 v[88:91], v1, s[12:15], s24 offen offset:0 sc1
    buffer_load_dwordx4 v[92:95], v1, s[12:15], s24 offen offset:1024 sc1
    s_xor_b32 s23, s31, 1
    s_lshl_b32 s28, s23, 12
    s_lshl_b32 s23, s23, 11
    s_add_u32 s23, s23, s29
    s_xor_b32 s24, s23, 0x8000
    buffer_load_dwordx4 v[32:35], v2, s[12:15], s28 offen offset:0 sc1
    buffer_load_dwordx4 v[36:39], v2, s[12:15], s28 offen offset:512 sc1
    buffer_load_dwordx4 v[40:43], v2, s[12:15], s28 offen offset:1024 sc1
    buffer_load_dwordx4 v[44:47], v2, s[12:15], s28 offen offset:1536 sc1
    buffer_load_dwordx4 v[96:99], v1, s[12:15], s23 offen offset:0 sc1
    buffer_load_dwordx4 v[100:103], v1, s[12:15], s23 offen offset:1024 sc1
    buffer_load_dwordx4 v[104:107], v1, s[12:15], s24 offen offset:0 sc1
    buffer_load_dwordx4 v[108:111], v1, s[12:15], s24 offen offset:1024 sc1
    v_lshlrev_b32 v144, 16, v248
    v_and_b32 v145, 0xffff0000, v248
    v_lshlrev_b32 v146, 16, v249
    v_and_b32 v147, 0xffff0000, v249
    v_lshlrev_b32 v148, 16, v250
    v_and_b32 v149, 0xffff0000, v250
    v_lshlrev_b32 v150, 16, v251
    v_and_b32 v151, 0xffff0000, v251
    v_lshlrev_b32 v152, 16, v252
    v_and_b32 v153, 0xffff0000, v252
    v_lshlrev_b32 v154, 16, v253
    v_and_b32 v155, 0xffff0000, v253
    v_lshlrev_b32 v156, 16, v254
    v_and_b32 v157, 0xffff0000, v254
    v_lshlrev_b32 v158, 16, v255
    v_and_b32 v159, 0xffff0000, v255
    s_waitcnt vmcnt(12)
    v_cvt_pk_bf16_f32 v16, v16, v17
    v_cvt_pk_bf16_f32 v17, v18, v19
    v_cvt_pk_bf16_f32 v18, v20, v21
    v_cvt_pk_bf16_f32 v19, v22, v23
    v_cvt_pk_bf16_f32 v20, v24, v25
    v_cvt_pk_bf16_f32 v21, v26, v27
    v_cvt_pk_bf16_f32 v22, v28, v29
    v_cvt_pk_bf16_f32 v23, v30, v31
    s_waitcnt vmcnt(8)
    s_nop 0
    v_mfma_f32_32x32x16_bf16 v[208:223], v[16:19], v[80:83], 0
    v_mfma_f32_32x32x16_bf16 v[208:223], v[20:23], v[84:87], v[208:223]
    v_mfma_f32_32x32x16_bf16 v[224:239], v[16:19], v[88:91], 0
    v_mfma_f32_32x32x16_bf16 v[224:239], v[20:23], v[92:95], v[224:239]
    s_waitcnt lgkmcnt(0)
    ds_read_b64_tr_b16 v[16:17], v14 offset:0
    ds_read_b64_tr_b16 v[18:19], v14 offset:512
    ds_read_b64_tr_b16 v[20:21], v15 offset:0
    ds_read_b64_tr_b16 v[22:23], v15 offset:512
    ds_read_b64_tr_b16 v[24:25], v14 offset:1024
    ds_read_b64_tr_b16 v[26:27], v14 offset:1536
    ds_read_b64_tr_b16 v[28:29], v15 offset:1024
    ds_read_b64_tr_b16 v[30:31], v15 offset:1536
    s_xor_b32 s23, s31, 2
    s_lshl_b32 s28, s23, 12
    s_lshl_b32 s23, s23, 11
    s_add_u32 s23, s23, s29
    s_xor_b32 s24, s23, 0x8000
    buffer_load_dwordx4 v[48:51], v2, s[12:15], s28 offen offset:0 sc1
    buffer_load_dwordx4 v[52:55], v2, s[12:15], s28 offen offset:512 sc1
    buffer_load_dwordx4 v[56:59], v2, s[12:15], s28 offen offset:1024 sc1
    buffer_load_dwordx4 v[60:63], v2, s[12:15], s28 offen offset:1536 sc1
    buffer_load_dwordx4 v[112:115], v1, s[12:15], s23 offen offset:0 sc1
    buffer_load_dwordx4 v[116:119], v1, s[12:15], s23 offen offset:1024 sc1
    buffer_load_dwordx4 v[120:123], v1, s[12:15], s24 offen offset:0 sc1
    buffer_load_dwordx4 v[124:127], v1, s[12:15], s24 offen offset:1024 sc1
    v_add_f32 v222, s26, v222
    v_rcp_f32 v222, v222
    v_mov_b32 v87, 0
    v_mul_f32 v222, s19, v222
    v_pk_mul_f32 v[208:209], v[208:209], v[222:223] op_sel_hi:[1,0]
    v_cvt_pk_bf16_f32 v80, v208, v209
    v_pk_mul_f32 v[210:211], v[210:211], v[222:223] op_sel_hi:[1,0]
    v_cvt_pk_bf16_f32 v81, v210, v211
    v_pk_mul_f32 v[212:213], v[212:213], v[222:223] op_sel_hi:[1,0]
    v_cvt_pk_bf16_f32 v82, v212, v213
    v_pk_mul_f32 v[214:215], v[214:215], v[222:223] op_sel_hi:[1,0]
    v_cvt_pk_bf16_f32 v83, v214, v215
    v_pk_mul_f32 v[216:217], v[216:217], v[222:223] op_sel_hi:[1,0]
    v_cvt_pk_bf16_f32 v84, v216, v217
    v_pk_mul_f32 v[218:219], v[218:219], v[222:223] op_sel_hi:[1,0]
    v_cvt_pk_bf16_f32 v85, v218, v219
    v_pk_mul_f32 v[220:221], v[220:221], v[222:223] op_sel_hi:[1,0]
    v_cvt_pk_bf16_f32 v86, v220, v221
    v_add_f32 v238, s26, v238
    v_rcp_f32 v238, v238
    v_mov_b32 v95, 0
    v_mul_f32 v238, s19, v238
    v_pk_mul_f32 v[224:225], v[224:225], v[238:239] op_sel_hi:[1,0]
    v_cvt_pk_bf16_f32 v88, v224, v225
    v_pk_mul_f32 v[226:227], v[226:227], v[238:239] op_sel_hi:[1,0]
    v_cvt_pk_bf16_f32 v89, v226, v227
    v_pk_mul_f32 v[228:229], v[228:229], v[238:239] op_sel_hi:[1,0]
    v_cvt_pk_bf16_f32 v90, v228, v229
    v_pk_mul_f32 v[230:231], v[230:231], v[238:239] op_sel_hi:[1,0]
    v_cvt_pk_bf16_f32 v91, v230, v231
    v_pk_mul_f32 v[232:233], v[232:233], v[238:239] op_sel_hi:[1,0]
    v_cvt_pk_bf16_f32 v92, v232, v233
    v_pk_mul_f32 v[234:235], v[234:235], v[238:239] op_sel_hi:[1,0]
    v_cvt_pk_bf16_f32 v93, v234, v235
    v_pk_mul_f32 v[236:237], v[236:237], v[238:239] op_sel_hi:[1,0]
    v_cvt_pk_bf16_f32 v94, v236, v237
    s_waitcnt vmcnt(12)
    v_cvt_pk_bf16_f32 v32, v32, v33
    v_cvt_pk_bf16_f32 v33, v34, v35
    v_cvt_pk_bf16_f32 v34, v36, v37
    v_cvt_pk_bf16_f32 v35, v38, v39
    v_cvt_pk_bf16_f32 v36, v40, v41
    v_cvt_pk_bf16_f32 v37, v42, v43
    v_cvt_pk_bf16_f32 v38, v44, v45
    v_cvt_pk_bf16_f32 v39, v46, v47
    s_waitcnt vmcnt(8)
    s_nop 0
    v_mfma_f32_32x32x16_bf16 v[208:223], v[32:35], v[96:99], 0
    v_mfma_f32_32x32x16_bf16 v[208:223], v[36:39], v[100:103], v[208:223]
    v_mfma_f32_32x32x16_bf16 v[224:239], v[32:35], v[104:107], 0
    v_mfma_f32_32x32x16_bf16 v[224:239], v[36:39], v[108:111], v[224:239]
    s_waitcnt lgkmcnt(0)
    ds_read_b64_tr_b16 v[32:33], v14 offset:4096
    ds_read_b64_tr_b16 v[34:35], v14 offset:4608
    ds_read_b64_tr_b16 v[36:37], v15 offset:4096
    ds_read_b64_tr_b16 v[38:39], v15 offset:4608
    ds_read_b64_tr_b16 v[40:41], v14 offset:5120
    ds_read_b64_tr_b16 v[42:43], v14 offset:5632
    ds_read_b64_tr_b16 v[44:45], v15 offset:5120
    ds_read_b64_tr_b16 v[46:47], v15 offset:5632
    s_xor_b32 s23, s31, 3
    s_lshl_b32 s28, s23, 12
    s_lshl_b32 s23, s23, 11
    s_add_u32 s23, s23, s29
    s_xor_b32 s24, s23, 0x8000
    buffer_load_dwordx4 v[64:67], v2, s[12:15], s28 offen offset:0 sc1
    buffer_load_dwordx4 v[68:71], v2, s[12:15], s28 offen offset:512 sc1
    buffer_load_dwordx4 v[72:75], v2, s[12:15], s28 offen offset:1024 sc1
    buffer_load_dwordx4 v[76:79], v2, s[12:15], s28 offen offset:1536 sc1
    buffer_load_dwordx4 v[128:131], v1, s[12:15], s23 offen offset:0 sc1
    buffer_load_dwordx4 v[132:135], v1, s[12:15], s23 offen offset:1024 sc1
    buffer_load_dwordx4 v[136:139], v1, s[12:15], s24 offen offset:0 sc1
    buffer_load_dwordx4 v[140:143], v1, s[12:15], s24 offen offset:1024 sc1
    s_barrier
    v_mfma_f32_32x32x16_bf16 v[144:159], v[16:19], v[80:83], v[144:159]
    v_mfma_f32_32x32x16_bf16 v[160:175], v[16:19], v[88:91], 0
    v_add_f32 v222, s26, v222
    v_rcp_f32 v222, v222
    v_mov_b32 v103, 0
    v_mul_f32 v222, s19, v222
    v_mul_f32 v208, v208, v222
    v_mul_f32 v209, v209, v222
    v_mfma_f32_32x32x16_bf16 v[176:191], v[20:23], v[80:83], 0
    v_cvt_pk_bf16_f32 v96, v208, v209
    v_mul_f32 v210, v210, v222
    v_mul_f32 v211, v211, v222
    v_cvt_pk_bf16_f32 v97, v210, v211
    v_mul_f32 v212, v212, v222
    v_mul_f32 v213, v213, v222
    v_mfma_f32_32x32x16_bf16 v[192:207], v[20:23], v[88:91], 0
    v_cvt_pk_bf16_f32 v98, v212, v213
    v_mul_f32 v214, v214, v222
    v_mul_f32 v215, v215, v222
    v_cvt_pk_bf16_f32 v99, v214, v215
    v_mul_f32 v216, v216, v222
    v_mul_f32 v217, v217, v222
    v_mfma_f32_32x32x16_bf16 v[144:159], v[24:27], v[84:87], v[144:159]
    v_cvt_pk_bf16_f32 v100, v216, v217
    v_mul_f32 v218, v218, v222
    v_mul_f32 v219, v219, v222
    v_cvt_pk_bf16_f32 v101, v218, v219
    v_mul_f32 v220, v220, v222
    v_mul_f32 v221, v221, v222
    v_mfma_f32_32x32x16_bf16 v[160:175], v[24:27], v[92:95], v[160:175]
    v_cvt_pk_bf16_f32 v102, v220, v221
    v_add_f32 v238, s26, v238
    v_rcp_f32 v238, v238
    v_mov_b32 v111, 0
    v_mul_f32 v238, s19, v238
    v_mul_f32 v224, v224, v238
    v_mfma_f32_32x32x16_bf16 v[176:191], v[28:31], v[84:87], v[176:191]
    v_mul_f32 v225, v225, v238
    v_cvt_pk_bf16_f32 v104, v224, v225
    v_mul_f32 v226, v226, v238
    v_mul_f32 v227, v227, v238
    v_cvt_pk_bf16_f32 v105, v226, v227
    v_mul_f32 v228, v228, v238
    v_mfma_f32_32x32x16_bf16 v[192:207], v[28:31], v[92:95], v[192:207]
    v_mul_f32 v229, v229, v238
    v_cvt_pk_bf16_f32 v106, v228, v229
    v_mul_f32 v230, v230, v238
    v_mul_f32 v231, v231, v238
    v_cvt_pk_bf16_f32 v107, v230, v231
    v_mul_f32 v232, v232, v238
    v_mul_f32 v233, v233, v238
    v_cvt_pk_bf16_f32 v108, v232, v233
    v_mul_f32 v234, v234, v238
    v_mul_f32 v235, v235, v238
    v_cvt_pk_bf16_f32 v109, v234, v235
    v_mul_f32 v236, v236, v238
    v_mul_f32 v237, v237, v238
    v_cvt_pk_bf16_f32 v110, v236, v237
    s_waitcnt vmcnt(12)
    v_cvt_pk_bf16_f32 v48, v48, v49
    v_cvt_pk_bf16_f32 v49, v50, v51
    v_cvt_pk_bf16_f32 v50, v52, v53
    v_cvt_pk_bf16_f32 v51, v54, v55
    v_cvt_pk_bf16_f32 v52, v56, v57
    v_cvt_pk_bf16_f32 v53, v58, v59
    v_cvt_pk_bf16_f32 v54, v60, v61
    v_cvt_pk_bf16_f32 v55, v62, v63
    s_waitcnt vmcnt(8)
    s_nop 0
    v_mfma_f32_32x32x16_bf16 v[208:223], v[48:51], v[112:115], 0
    v_mfma_f32_32x32x16_bf16 v[208:223], v[52:55], v[116:119], v[208:223]
    v_mfma_f32_32x32x16_bf16 v[224:239], v[48:51], v[120:123], 0
    v_mfma_f32_32x32x16_bf16 v[224:239], v[52:55], v[124:127], v[224:239]
    s_waitcnt lgkmcnt(0)
    ds_read_b64_tr_b16 v[48:49], v14 offset:8192
    ds_read_b64_tr_b16 v[50:51], v14 offset:8704
    ds_read_b64_tr_b16 v[52:53], v15 offset:8192
    ds_read_b64_tr_b16 v[54:55], v15 offset:8704
    ds_read_b64_tr_b16 v[56:57], v14 offset:9216
    ds_read_b64_tr_b16 v[58:59], v14 offset:9728
    ds_read_b64_tr_b16 v[60:61], v15 offset:9216
    ds_read_b64_tr_b16 v[62:63], v15 offset:9728
    v_mfma_f32_32x32x16_bf16 v[144:159], v[32:35], v[96:99], v[144:159]
    v_mfma_f32_32x32x16_bf16 v[160:175], v[32:35], v[104:107], v[160:175]
    v_add_f32 v222, s26, v222
    v_rcp_f32 v222, v222
    v_mov_b32 v119, 0
    v_mul_f32 v222, s19, v222
    v_mul_f32 v208, v208, v222
    v_mul_f32 v209, v209, v222
    v_mfma_f32_32x32x16_bf16 v[176:191], v[36:39], v[96:99], v[176:191]
    v_cvt_pk_bf16_f32 v112, v208, v209
    v_mul_f32 v210, v210, v222
    v_mul_f32 v211, v211, v222
    v_cvt_pk_bf16_f32 v113, v210, v211
    v_mul_f32 v212, v212, v222
    v_mul_f32 v213, v213, v222
    v_mfma_f32_32x32x16_bf16 v[192:207], v[36:39], v[104:107], v[192:207]
    v_cvt_pk_bf16_f32 v114, v212, v213
    v_mul_f32 v214, v214, v222
    v_mul_f32 v215, v215, v222
    v_cvt_pk_bf16_f32 v115, v214, v215
    v_mul_f32 v216, v216, v222
    v_mul_f32 v217, v217, v222
    v_mfma_f32_32x32x16_bf16 v[144:159], v[40:43], v[100:103], v[144:159]
    v_cvt_pk_bf16_f32 v116, v216, v217
    v_mul_f32 v218, v218, v222
    v_mul_f32 v219, v219, v222
    v_cvt_pk_bf16_f32 v117, v218, v219
    v_mul_f32 v220, v220, v222
    v_mul_f32 v221, v221, v222
    v_mfma_f32_32x32x16_bf16 v[160:175], v[40:43], v[108:111], v[160:175]
    v_cvt_pk_bf16_f32 v118, v220, v221
    v_add_f32 v238, s26, v238
    v_rcp_f32 v238, v238
    v_mov_b32 v127, 0
    v_mul_f32 v238, s19, v238
    v_mul_f32 v224, v224, v238
    v_mfma_f32_32x32x16_bf16 v[176:191], v[44:47], v[100:103], v[176:191]
    v_mul_f32 v225, v225, v238
    v_cvt_pk_bf16_f32 v120, v224, v225
    v_mul_f32 v226, v226, v238
    v_mul_f32 v227, v227, v238
    v_cvt_pk_bf16_f32 v121, v226, v227
    v_mul_f32 v228, v228, v238
    v_mfma_f32_32x32x16_bf16 v[192:207], v[44:47], v[108:111], v[192:207]
    v_mul_f32 v229, v229, v238
    v_cvt_pk_bf16_f32 v122, v228, v229
    v_mul_f32 v230, v230, v238
    v_mul_f32 v231, v231, v238
    v_cvt_pk_bf16_f32 v123, v230, v231
    v_mul_f32 v232, v232, v238
    v_mul_f32 v233, v233, v238
    v_cvt_pk_bf16_f32 v124, v232, v233
    v_mul_f32 v234, v234, v238
    v_mul_f32 v235, v235, v238
    v_cvt_pk_bf16_f32 v125, v234, v235
    v_mul_f32 v236, v236, v238
    v_mul_f32 v237, v237, v238
    v_cvt_pk_bf16_f32 v126, v236, v237
    s_waitcnt vmcnt(4)
    v_cvt_pk_bf16_f32 v64, v64, v65
    v_cvt_pk_bf16_f32 v65, v66, v67
    v_cvt_pk_bf16_f32 v66, v68, v69
    v_cvt_pk_bf16_f32 v67, v70, v71
    v_cvt_pk_bf16_f32 v68, v72, v73
    v_cvt_pk_bf16_f32 v69, v74, v75
    v_cvt_pk_bf16_f32 v70, v76, v77
    v_cvt_pk_bf16_f32 v71, v78, v79
    s_waitcnt vmcnt(0)
    s_nop 0
    v_mfma_f32_32x32x16_bf16 v[208:223], v[64:67], v[128:131], 0
    v_mfma_f32_32x32x16_bf16 v[208:223], v[68:71], v[132:135], v[208:223]
    v_mfma_f32_32x32x16_bf16 v[224:239], v[64:67], v[136:139], 0
    v_mfma_f32_32x32x16_bf16 v[224:239], v[68:71], v[140:143], v[224:239]
    s_waitcnt lgkmcnt(0)
    ds_read_b64_tr_b16 v[64:65], v14 offset:12288
    ds_read_b64_tr_b16 v[66:67], v14 offset:12800
    ds_read_b64_tr_b16 v[68:69], v15 offset:12288
    ds_read_b64_tr_b16 v[70:71], v15 offset:12800
    ds_read_b64_tr_b16 v[72:73], v14 offset:13312
    ds_read_b64_tr_b16 v[74:75], v14 offset:13824
    ds_read_b64_tr_b16 v[76:77], v15 offset:13312
    ds_read_b64_tr_b16 v[78:79], v15 offset:13824
    v_mfma_f32_32x32x16_bf16 v[160:175], v[48:51], v[120:123], v[160:175]
    v_mfma_f32_32x32x16_bf16 v[176:191], v[52:55], v[112:115], v[176:191]
    v_add_f32 v222, s26, v222
    v_rcp_f32 v222, v222
    v_mov_b32 v135, 0
    v_mul_f32 v222, s19, v222
    v_mul_f32 v208, v208, v222
    v_mul_f32 v209, v209, v222
    v_mfma_f32_32x32x16_bf16 v[192:207], v[52:55], v[120:123], v[192:207]
    v_cvt_pk_bf16_f32 v128, v208, v209
    v_mul_f32 v210, v210, v222
    v_mul_f32 v211, v211, v222
    v_cvt_pk_bf16_f32 v129, v210, v211
    v_mul_f32 v212, v212, v222
    v_mul_f32 v213, v213, v222
    v_mfma_f32_32x32x16_bf16 v[160:175], v[56:59], v[124:127], v[160:175]
    v_cvt_pk_bf16_f32 v130, v212, v213
    v_mul_f32 v214, v214, v222
    v_mul_f32 v215, v215, v222
    v_cvt_pk_bf16_f32 v131, v214, v215
    v_mul_f32 v216, v216, v222
    v_mul_f32 v217, v217, v222
    v_mfma_f32_32x32x16_bf16 v[176:191], v[60:63], v[116:119], v[176:191]
    v_cvt_pk_bf16_f32 v132, v216, v217
    v_mul_f32 v218, v218, v222
    v_mul_f32 v219, v219, v222
    v_cvt_pk_bf16_f32 v133, v218, v219
    v_mul_f32 v220, v220, v222
    v_mul_f32 v221, v221, v222
    v_mfma_f32_32x32x16_bf16 v[192:207], v[60:63], v[124:127], v[192:207]
    v_cvt_pk_bf16_f32 v134, v220, v221
    v_add_f32 v238, s26, v238
    v_rcp_f32 v238, v238
    v_mov_b32 v143, 0
    v_mul_f32 v238, s19, v238
    v_mul_f32 v224, v224, v238
    v_mul_f32 v225, v225, v238
    v_cvt_pk_bf16_f32 v136, v224, v225
    v_mul_f32 v226, v226, v238
    v_mul_f32 v227, v227, v238
    v_cvt_pk_bf16_f32 v137, v226, v227
    v_mul_f32 v228, v228, v238
    v_mul_f32 v229, v229, v238
    v_cvt_pk_bf16_f32 v138, v228, v229
    v_mul_f32 v230, v230, v238
    v_mul_f32 v231, v231, v238
    v_cvt_pk_bf16_f32 v139, v230, v231
    v_mul_f32 v232, v232, v238
    v_mul_f32 v233, v233, v238
    v_cvt_pk_bf16_f32 v140, v232, v233
    v_mul_f32 v234, v234, v238
    v_mul_f32 v235, v235, v238
    v_cvt_pk_bf16_f32 v141, v234, v235
    v_mul_f32 v236, v236, v238
    v_mul_f32 v237, v237, v238
    v_cvt_pk_bf16_f32 v142, v236, v237
    s_waitcnt lgkmcnt(0)
    s_nop 0
    v_mfma_f32_32x32x16_bf16 v[192:207], v[68:71], v[136:139], v[192:207]
    v_mfma_f32_32x32x16_bf16 v[192:207], v[76:79], v[140:143], v[192:207]
    v_mfma_f32_32x32x16_bf16 v[176:191], v[68:71], v[128:131], v[176:191]
    v_mfma_f32_32x32x16_bf16 v[176:191], v[76:79], v[132:135], v[176:191]
    v_mfma_f32_32x32x16_bf16 v[160:175], v[64:67], v[136:139], v[160:175]
    v_mfma_f32_32x32x16_bf16 v[160:175], v[72:75], v[140:143], v[160:175]
    v_mfma_f32_32x32x16_bf16 v[144:159], v[48:51], v[112:115], v[144:159]
    v_mfma_f32_32x32x16_bf16 v[144:159], v[56:59], v[116:119], v[144:159]
    s_nop 5
    ds_write_b128 v8, v[192:195] offset:8192
    ds_write_b128 v8, v[196:199] offset:9216
    ds_write_b128 v8, v[200:203] offset:10240
    ds_write_b128 v8, v[204:207] offset:11264
    v_mfma_f32_32x32x16_bf16 v[144:159], v[64:67], v[128:131], v[144:159]
    ds_write_b128 v8, v[176:179] offset:4096
    ds_write_b128 v8, v[180:183] offset:5120
    ds_write_b128 v8, v[184:187] offset:6144
    ds_write_b128 v8, v[188:191] offset:7168
    v_mfma_f32_32x32x16_bf16 v[144:159], v[72:75], v[132:135], v[144:159]
    ds_write_b128 v8, v[160:163] offset:0
    ds_write_b128 v8, v[164:167] offset:1024
    ds_write_b128 v8, v[168:171] offset:2048
    ds_write_b128 v8, v[172:175] offset:3072
    s_mov_b32 s23, s74
    s_mov_b32 s24, s75
    v_mov_b32 v4, 0
    v_mov_b32 v5, 0
    s_waitcnt lgkmcnt(0)
    s_barrier
    ds_read_b128 v[16:19], v11 offset:0
    ds_read_b128 v[20:23], v11 offset:1024
    ds_read_b128 v[24:27], v11 offset:2048
    ds_read_b128 v[28:31], v11 offset:3072
    ds_read_b128 v[32:35], v12 offset:4096
    ds_read_b128 v[36:39], v12 offset:5120
    ds_read_b128 v[40:43], v12 offset:6144
    ds_read_b128 v[44:47], v12 offset:7168
    ds_read_b128 v[48:51], v13 offset:8192
    ds_read_b128 v[52:55], v13 offset:9216
    ds_read_b128 v[56:59], v13 offset:10240
    ds_read_b128 v[60:63], v13 offset:11264
    s_waitcnt lgkmcnt(8)
    v_pk_add_f32 v[144:145], v[144:145], v[16:17]
    v_pk_add_f32 v[146:147], v[146:147], v[18:19]
    v_pk_add_f32 v[148:149], v[148:149], v[20:21]
    v_pk_add_f32 v[150:151], v[150:151], v[22:23]
    v_pk_add_f32 v[152:153], v[152:153], v[24:25]
    v_pk_add_f32 v[154:155], v[154:155], v[26:27]
    v_pk_add_f32 v[156:157], v[156:157], v[28:29]
    v_pk_add_f32 v[158:159], v[158:159], v[30:31]
    s_waitcnt lgkmcnt(4)
    v_pk_add_f32 v[144:145], v[144:145], v[32:33]
    v_pk_add_f32 v[146:147], v[146:147], v[34:35]
    v_pk_add_f32 v[148:149], v[148:149], v[36:37]
    v_pk_add_f32 v[150:151], v[150:151], v[38:39]
    v_pk_add_f32 v[152:153], v[152:153], v[40:41]
    v_pk_add_f32 v[154:155], v[154:155], v[42:43]
    v_pk_add_f32 v[156:157], v[156:157], v[44:45]
    v_pk_add_f32 v[158:159], v[158:159], v[46:47]
    s_waitcnt lgkmcnt(0)
    v_pk_add_f32 v[144:145], v[144:145], v[48:49]
    v_pk_add_f32 v[146:147], v[146:147], v[50:51]
    v_pk_add_f32 v[148:149], v[148:149], v[52:53]
    v_pk_add_f32 v[150:151], v[150:151], v[54:55]
    v_pk_add_f32 v[152:153], v[152:153], v[56:57]
    v_pk_add_f32 v[154:155], v[154:155], v[58:59]
    v_pk_add_f32 v[156:157], v[156:157], v[60:61]
    v_pk_add_f32 v[158:159], v[158:159], v[62:63]
    v_cvt_pk_bf16_f32 v96, v144, v145
    v_cvt_pk_bf16_f32 v97, v146, v147
    v_cvt_pk_bf16_f32 v98, v148, v149
    v_cvt_pk_bf16_f32 v99, v150, v151
    v_cvt_pk_bf16_f32 v100, v152, v153
    v_cvt_pk_bf16_f32 v101, v154, v155
    v_cvt_pk_bf16_f32 v102, v156, v157
    v_cvt_pk_bf16_f32 v103, v158, v159
    buffer_store_dwordx4 v[96:99], v1, s[12:15], s23 offen sc1
    buffer_store_dwordx4 v[100:103], v1, s[12:15], s23 offen offset:1024 sc1
    v_dot2c_f32_bf16 v4, s27, v96
    v_dot2c_f32_bf16 v5, v96, v96
    v_dot2c_f32_bf16 v4, s27, v97
    v_dot2c_f32_bf16 v5, v97, v97
    v_dot2c_f32_bf16 v4, s27, v98
    v_dot2c_f32_bf16 v5, v98, v98
    v_dot2c_f32_bf16 v4, s27, v99
    v_dot2c_f32_bf16 v5, v99, v99
    v_dot2c_f32_bf16 v4, s27, v100
    v_dot2c_f32_bf16 v5, v100, v100
    v_dot2c_f32_bf16 v4, s27, v101
    v_dot2c_f32_bf16 v5, v101, v101
    v_dot2c_f32_bf16 v4, s27, v102
    v_dot2c_f32_bf16 v5, v102, v102
    v_dot2c_f32_bf16 v4, s27, v103
    v_dot2c_f32_bf16 v5, v103, v103
    v_and_b32 v6, 31, v0
    v_lshlrev_b32 v6, 3, v6
    s_lshr_b32 s23, s21, 2
    v_mov_b32 v12, v4
    v_mov_b32 v13, v5
    s_mul_i32 s23, s23, 3584
    s_add_u32 s23, s23, 11583488
    v_permlane32_swap_b32 v4, v12
    v_permlane32_swap_b32 v5, v13
    s_nop 0
    v_add_f32 v4, v4, v12
    v_add_f32 v5, v5, v13
    s_mov_b32 exec_hi, 0
    buffer_store_dwordx2 v[4:5], v6, s[12:15], s24 offen sc1
    s_mov_b64 exec, -1
    s_waitcnt vmcnt(0)
    s_barrier
    s_lshr_b32 s28, s2, 3
    s_cmp_lg_u32 s20, 0
    s_cbranch_scc1 Lkf_sg1
    v_lshlrev_b32 v7, 7, v0
    v_mov_b32 v8, 1
    s_mov_b64 exec, 268435455
    buffer_atomic_add v8, v7, s[12:15], s23 offen sc1
    s_mov_b64 exec, -1
Lkf_sg1:
    s_branch Lkf_cc
Lkf_ld:
    s_lshl_b32 s23, s34, 1
    s_add_u32 s23, s23, s22
    s_mul_i32 s24, s23, 37
    s_lshr_b32 s24, s24, 8
    s_mul_i32 s18, s24, 7
    s_sub_u32 s18, s23, s18
    s_and_b32 s24, s2, 3
    s_mul_i32 s24, s24, 7
    s_add_u32 s16, s22, s24
    s_mov_b32 s58, 1605632
    s_mov_b32 s59, 0x20000
    s_mov_b32 s62, 1606656
    s_mov_b32 s63, 0x20000
    v_bfe_u32 v6, v0, 3, 3
    v_bfe_u32 v7, v0, 6, 2
    v_lshl_add_u32 v6, v7, 4, v6
    v_and_b32 v8, 7, v0
    v_bfe_u32 v7, v0, 4, 1
    v_lshlrev_b32 v7, 2, v7
    v_xor_b32 v7, v7, v8
    v_mul_u32_u24 v2, 3584, v6
    v_lshl_add_u32 v2, v7, 4, v2
    v_add_u32 v3, 26624, v2
    s_lshl_b32 s32, s16, 7
    s_mul_i32 s23, s18, 229376
    s_add_u32 s32, s32, s23
    s_mov_b32 s33, s18
    s_and_b32 s23, s20, 3
    s_lshl_b32 m0, s23, 12
    s_waitcnt lgkmcnt(0)
    s_sub_u32 s60, s60, 1024
    s_subb_u32 s61, s61, 0
    s_barrier
    s_barrier
    buffer_load_dwordx4 v2, s[56:59], s32 offen lds
    buffer_load_dwordx4 v2, s[60:63], s32 offen offset:1024 lds
    buffer_load_dwordx4 v3, s[56:59], s32 offen offset:2048 lds
    buffer_load_dwordx4 v3, s[60:63], s32 offen offset:3072 lds
    s_add_u32 m0, m0, 16384
    s_add_u32 s33, s33, 1
    s_cmp_eq_u32 s33, 7
    s_cselect_b32 s23, -6, 1
    s_mul_i32 s23, s23, 229376
    s_add_u32 s32, s32, s23
    buffer_load_dwordx4 v2, s[56:59], s32 offen lds
    buffer_load_dwordx4 v2, s[60:63], s32 offen offset:1024 lds
    buffer_load_dwordx4 v3, s[56:59], s32 offen offset:2048 lds
    buffer_load_dwordx4 v3, s[60:63], s32 offen offset:3072 lds
    s_add_u32 m0, m0, 16384
    s_add_u32 s33, s33, 1
    s_cmp_eq_u32 s33, 7
    s_cselect_b32 s23, -6, 1
    s_mul_i32 s23, s23, 229376
    s_add_u32 s32, s32, s23
    buffer_load_dwordx4 v2, s[56:59], s32 offen lds
    buffer_load_dwordx4 v2, s[60:63], s32 offen offset:1024 lds
    buffer_load_dwordx4 v3, s[56:59], s32 offen offset:2048 lds
    buffer_load_dwordx4 v3, s[60:63], s32 offen offset:3072 lds
    s_add_u32 m0, m0, 16384
    s_add_u32 s33, s33, 1
    s_cmp_eq_u32 s33, 7
    s_cselect_b32 s23, -6, 1
    s_mul_i32 s23, s23, 229376
    s_add_u32 s32, s32, s23
    s_barrier
    buffer_load_dwordx4 v2, s[56:59], s32 offen lds
    buffer_load_dwordx4 v2, s[60:63], s32 offen offset:1024 lds
    buffer_load_dwordx4 v3, s[56:59], s32 offen offset:2048 lds
    buffer_load_dwordx4 v3, s[60:63], s32 offen offset:3072 lds
    s_add_u32 m0, m0, 16384
    s_add_u32 s33, s33, 1
    s_cmp_eq_u32 s33, 7
    s_cselect_b32 s23, -6, 1
    s_mul_i32 s23, s23, 229376
    s_add_u32 s32, s32, s23
    buffer_load_dwordx4 v2, s[56:59], s32 offen lds
    buffer_load_dwordx4 v2, s[60:63], s32 offen offset:1024 lds
    buffer_load_dwordx4 v3, s[56:59], s32 offen offset:2048 lds
    buffer_load_dwordx4 v3, s[60:63], s32 offen offset:3072 lds
    s_add_u32 m0, m0, 16384
    s_add_u32 s33, s33, 1
    s_cmp_eq_u32 s33, 7
    s_cselect_b32 s23, -6, 1
    s_mul_i32 s23, s23, 229376
    s_add_u32 s32, s32, s23
    buffer_load_dwordx4 v2, s[56:59], s32 offen lds
    buffer_load_dwordx4 v2, s[60:63], s32 offen offset:1024 lds
    buffer_load_dwordx4 v3, s[56:59], s32 offen offset:2048 lds
    buffer_load_dwordx4 v3, s[60:63], s32 offen offset:3072 lds
    s_barrier
    s_branch Lkf_cj
Lkf_cc:
    s_lshl_b32 s23, s34, 1
    s_add_u32 s23, s23, s22
    s_mul_i32 s24, s23, 37
    s_lshr_b32 s24, s24, 8
    s_mul_i32 s18, s24, 7
    s_sub_u32 s18, s23, s18
    s_and_b32 s24, s2, 3
    s_mul_i32 s24, s24, 7
    s_add_u32 s16, s22, s24
    s_mov_b32 s58, 1605632
    s_mov_b32 s59, 0x20000
    s_mov_b32 s62, 1606656
    s_mov_b32 s63, 0x20000
    s_sub_u32 s60, s60, 1024
    s_subb_u32 s61, s61, 0
Lkf_cj:
    s_and_b32 s23, s2, 4
    s_add_u32 s23, s23, s34
    s_lshl_b32 s17, s23, 3
    s_add_u32 s17, s17, s20
    s_mul_i32 s29, s23, 28
    s_add_u32 s73, s29, s16
    s_lshl_b32 s73, s73, 7
    s_add_u32 s73, s73, 11583488
    s_mul_i32 s33, s17, 28672
    s_lshl_b32 s23, s18, 12
    s_add_u32 s33, s33, s23
    s_add_u32 s33, s33, 2162688
    s_add_u32 s23, s18, 6
    s_cmp_ge_u32 s23, 7
    s_cselect_b32 s24, 7, 0
    s_sub_u32 s23, s23, s24
    s_mul_i32 s23, s23, 229376
    s_lshl_b32 s32, s16, 7
    s_add_u32 s32, s32, s23
    v_lshrrev_b32 v6, 3, v0
    v_and_b32 v8, 7, v0
    v_bfe_u32 v7, v0, 4, 1
    v_lshlrev_b32 v4, 2, v7
    v_xor_b32 v4, v4, v8
    v_mul_u32_u24 v3, 3584, v6
    v_lshl_add_u32 v3, v4, 4, v3
    v_bfe_u32 v7, v0, 7, 2
    v_mul_u32_u24 v7, 448, v7
    v_bfe_u32 v6, v0, 3, 3
    v_add_u32 v6, v6, v7
    v_bfe_u32 v7, v0, 6, 1
    v_lshl_add_u32 v6, v7, 4, v6
    v_mul_u32_u24 v14, 896, v6
    v_lshl_add_u32 v14, v4, 4, v14
    v_add_u32 v15, 6144, v14
    v_bfe_u32 v7, v0, 2, 2
    v_lshlrev_b32 v6, 12, v9
    v_lshl_add_u32 v6, v7, 7, v6
    v_lshrrev_b32 v7, 1, v7
    v_lshl_add_u32 v6, v7, 6, v6
    v_and_b32 v7, 1, v0
    v_lshl_add_u32 v6, v7, 5, v6
    v_bfe_u32 v7, v0, 4, 1
    v_lshl_add_u32 v6, v7, 4, v6
    v_bfe_u32 v7, v0, 1, 1
    v_lshl_add_u32 v10, v7, 3, v6
    v_xor_b32 v11, 64, v10
    v_add_u32 v12, 0x10000, v10
    v_add_u32 v13, 0x10000, v11
    v_and_b32 v6, 31, v0
    v_mul_u32_u24 v4, 1792, v9
    v_lshl_add_u32 v4, v6, 3, v4
    v_bfe_u32 v7, v0, 2, 1
    v_bfe_u32 v8, v0, 3, 2
    v_lshlrev_b32 v7, 4, v7
    v_lshl_add_u32 v7, v8, 2, v7
    v_and_b32 v8, 3, v0
    v_add_lshl_u32 v2, v7, v8, 2
    s_mul_i32 s23, s34, 7
    s_lshr_b32 s23, s23, 1
    s_lshl_b32 s35, s22, 1
    s_add_u32 s35, s35, s23
    s_cmp_ge_u32 s35, 14
    s_cselect_b32 s23, 14, 0
    s_sub_u32 s35, s35, s23
    s_mul_i32 s23, s35, 28672
    s_add_u32 s36, s30, s23
    s_mov_b32 s31, s35
    s_mul_i32 s23, s17, 3584
    s_add_u32 s23, s23, 3997696
    s_lshl_b32 s24, s16, 8
    s_add_u32 s24, s24, 4227072
    s_add_u32 s28, s24, 7168
    s_mov_b32 s66, 1605632
    s_mov_b32 s67, 0x20000
    s_mov_b32 s70, 1835008
    s_mov_b32 s71, 0x20000
    s_cmp_lg_u32 s20, 4
    s_cbranch_scc1 Lkf_p1dr
    s_mov_b32 s72, 0x200000
    v_mov_b32 v5, 0
Lkf_p1:
    buffer_load_dword v6, v5, s[12:15], s73 offen sc1
    s_waitcnt vmcnt(0)
    v_cmp_gt_u32 vcc, 28, v6
    s_cbranch_vccz Lkf_p1ok
    s_sleep 1
    s_sub_u32 s72, s72, 1
    s_cbranch_scc0 Lkf_p1
Lkf_p1ok:
    s_barrier
    s_lshl_b32 s25, s20, 11
    s_add_u32 m0, s25, 98304
    s_nop 0
    buffer_load_dwordx4 v3, s[56:59], s32 offen lds
    buffer_load_dwordx4 v3, s[60:63], s32 offen offset:1024 lds
    s_branch Lkf_p1j
Lkf_p1dr:
    s_lshl_b32 s25, s20, 11
    s_add_u32 m0, s25, 98304
    s_nop 0
    buffer_load_dwordx4 v3, s[56:59], s32 offen lds
    buffer_load_dwordx4 v3, s[60:63], s32 offen offset:1024 lds
    s_waitcnt vmcnt(2)
    s_barrier
Lkf_p1j:
    buffer_load_dwordx4 v[16:19], v1, s[12:15], s33 offen offset:0 sc1
    buffer_load_dwordx4 v[20:23], v1, s[12:15], s33 offen offset:1024 sc1
    s_barrier
    buffer_load_dwordx4 v[24:27], v1, s[12:15], s33 offen offset:2048 sc1
    buffer_load_dwordx4 v[28:31], v1, s[12:15], s33 offen offset:3072 sc1
    s_add_u32 s18, s18, 1
    s_cmp_eq_u32 s18, 7
    s_cselect_b32 s25, -6, 1
    s_lshl_b32 s25, s25, 12
    s_add_u32 s33, s33, s25
    buffer_load_dwordx4 v[32:35], v1, s[12:15], s33 offen offset:0 sc1
    buffer_load_dwordx4 v[36:39], v1, s[12:15], s33 offen offset:1024 sc1
    buffer_load_dwordx4 v[40:43], v1, s[12:15], s33 offen offset:2048 sc1
    buffer_load_dwordx4 v[44:47], v1, s[12:15], s33 offen offset:3072 sc1
    ds_read_b64_tr_b16 v[192:193], v10 offset:0
    ds_read_b64_tr_b16 v[194:195], v10 offset:512
    ds_read_b64_tr_b16 v[196:197], v11 offset:0
    ds_read_b64_tr_b16 v[198:199], v11 offset:512
    ds_read_b64_tr_b16 v[200:201], v10 offset:1024
    ds_read_b64_tr_b16 v[202:203], v10 offset:1536
    ds_read_b64_tr_b16 v[204:205], v11 offset:1024
    ds_read_b64_tr_b16 v[206:207], v11 offset:1536
    ds_read_b64_tr_b16 v[236:237], v10 offset:2048
    ds_read_b64_tr_b16 v[238:239], v10 offset:2560
    ds_read_b64_tr_b16 v[240:241], v11 offset:2048
    ds_read_b64_tr_b16 v[242:243], v11 offset:2560
    ds_read_b64_tr_b16 v[244:245], v10 offset:3072
    ds_read_b64_tr_b16 v[246:247], v10 offset:3584
    s_waitcnt vmcnt(7)
    s_waitcnt lgkmcnt(12)
    v_mfma_f32_32x32x16_bf16 v[128:143], v[192:195], v[16:19], 0
    ds_read_b64_tr_b16 v[192:193], v11 offset:3072
    ds_read_b64_tr_b16 v[194:195], v11 offset:3584
    s_add_u32 s18, s18, 1
    s_cmp_eq_u32 s18, 7
    s_cselect_b32 s25, -6, 1
    s_lshl_b32 s25, s25, 12
    s_add_u32 s33, s33, s25
    buffer_load_dwordx4 v[48:51], v1, s[12:15], s33 offen offset:0 sc1
    s_waitcnt lgkmcnt(12)
    v_mfma_f32_32x32x16_bf16 v[144:159], v[196:199], v[16:19], 0
    ds_read_b64_tr_b16 v[196:197], v10 offset:8192
    ds_read_b64_tr_b16 v[198:199], v10 offset:8704
    s_waitcnt lgkmcnt(12)
    v_mfma_f32_32x32x16_bf16 v[160:175], v[200:203], v[16:19], 0
    ds_read_b64_tr_b16 v[200:201], v11 offset:8192
    ds_read_b64_tr_b16 v[202:203], v11 offset:8704
    buffer_load_dwordx4 v[52:55], v1, s[12:15], s33 offen offset:1024 sc1
    s_waitcnt lgkmcnt(12)
    v_mfma_f32_32x32x16_bf16 v[176:191], v[204:207], v[16:19], 0
    ds_read_b64_tr_b16 v[204:205], v10 offset:9216
    ds_read_b64_tr_b16 v[206:207], v10 offset:9728
    s_waitcnt vmcnt(8)
    s_waitcnt lgkmcnt(12)
    v_mfma_f32_32x32x16_bf16 v[128:143], v[236:239], v[20:23], v[128:143]
    ds_read_b64_tr_b16 v[236:237], v11 offset:9216
    ds_read_b64_tr_b16 v[238:239], v11 offset:9728
    buffer_load_dwordx4 v[56:59], v1, s[12:15], s33 offen offset:2048 sc1
    s_waitcnt lgkmcnt(12)
    v_mfma_f32_32x32x16_bf16 v[144:159], v[240:243], v[20:23], v[144:159]
    ds_read_b64_tr_b16 v[240:241], v10 offset:10240
    ds_read_b64_tr_b16 v[242:243], v10 offset:10752
    s_waitcnt lgkmcnt(12)
    v_mfma_f32_32x32x16_bf16 v[160:175], v[244:247], v[20:23], v[160:175]
    ds_read_b64_tr_b16 v[244:245], v11 offset:10240
    ds_read_b64_tr_b16 v[246:247], v11 offset:10752
    buffer_load_dwordx4 v[60:63], v1, s[12:15], s33 offen offset:3072 sc1
    s_waitcnt lgkmcnt(12)
    v_mfma_f32_32x32x16_bf16 v[176:191], v[192:195], v[20:23], v[176:191]
    ds_read_b64_tr_b16 v[192:193], v10 offset:11264
    ds_read_b64_tr_b16 v[194:195], v10 offset:11776
    s_waitcnt vmcnt(9)
    s_waitcnt lgkmcnt(12)
    v_mfma_f32_32x32x16_bf16 v[128:143], v[196:199], v[24:27], v[128:143]
    ds_read_b64_tr_b16 v[196:197], v11 offset:11264
    ds_read_b64_tr_b16 v[198:199], v11 offset:11776
    s_add_u32 s18, s18, 1
    s_cmp_eq_u32 s18, 7
    s_cselect_b32 s25, -6, 1
    s_lshl_b32 s25, s25, 12
    s_add_u32 s33, s33, s25
    buffer_load_dwordx4 v[64:67], v1, s[12:15], s33 offen offset:0 sc1
    s_waitcnt lgkmcnt(12)
    v_mfma_f32_32x32x16_bf16 v[144:159], v[200:203], v[24:27], v[144:159]
    ds_read_b64_tr_b16 v[200:201], v10 offset:16384
    ds_read_b64_tr_b16 v[202:203], v10 offset:16896
    s_waitcnt lgkmcnt(12)
    v_mfma_f32_32x32x16_bf16 v[160:175], v[204:207], v[24:27], v[160:175]
    ds_read_b64_tr_b16 v[204:205], v11 offset:16384
    ds_read_b64_tr_b16 v[206:207], v11 offset:16896
    buffer_load_dwordx4 v[68:71], v1, s[12:15], s33 offen offset:1024 sc1
    s_waitcnt lgkmcnt(12)
    v_mfma_f32_32x32x16_bf16 v[176:191], v[236:239], v[24:27], v[176:191]
    ds_read_b64_tr_b16 v[236:237], v10 offset:17408
    ds_read_b64_tr_b16 v[238:239], v10 offset:17920
    s_waitcnt vmcnt(10)
    s_waitcnt lgkmcnt(12)
    v_mfma_f32_32x32x16_bf16 v[128:143], v[240:243], v[28:31], v[128:143]
    ds_read_b64_tr_b16 v[240:241], v11 offset:17408
    ds_read_b64_tr_b16 v[242:243], v11 offset:17920
    buffer_load_dwordx4 v[72:75], v1, s[12:15], s33 offen offset:2048 sc1
    s_waitcnt lgkmcnt(12)
    v_mfma_f32_32x32x16_bf16 v[144:159], v[244:247], v[28:31], v[144:159]
    ds_read_b64_tr_b16 v[244:245], v10 offset:18432
    ds_read_b64_tr_b16 v[246:247], v10 offset:18944
    s_waitcnt lgkmcnt(12)
    v_mfma_f32_32x32x16_bf16 v[160:175], v[192:195], v[28:31], v[160:175]
    ds_read_b64_tr_b16 v[192:193], v11 offset:18432
    ds_read_b64_tr_b16 v[194:195], v11 offset:18944
    buffer_load_dwordx4 v[76:79], v1, s[12:15], s33 offen offset:3072 sc1
    s_waitcnt lgkmcnt(12)
    v_mfma_f32_32x32x16_bf16 v[176:191], v[196:199], v[28:31], v[176:191]
    ds_read_b64_tr_b16 v[196:197], v10 offset:19456
    ds_read_b64_tr_b16 v[198:199], v10 offset:19968
    s_waitcnt vmcnt(11)
    s_waitcnt lgkmcnt(12)
    v_mfma_f32_32x32x16_bf16 v[128:143], v[200:203], v[32:35], v[128:143]
    ds_read_b64_tr_b16 v[200:201], v11 offset:19456
    ds_read_b64_tr_b16 v[202:203], v11 offset:19968
    s_add_u32 s18, s18, 1
    s_cmp_eq_u32 s18, 7
    s_cselect_b32 s25, -6, 1
    s_lshl_b32 s25, s25, 12
    s_add_u32 s33, s33, s25
    buffer_load_dwordx4 v[80:83], v1, s[12:15], s33 offen offset:0 sc1
    s_waitcnt lgkmcnt(12)
    v_mfma_f32_32x32x16_bf16 v[144:159], v[204:207], v[32:35], v[144:159]
    ds_read_b64_tr_b16 v[204:205], v10 offset:24576
    ds_read_b64_tr_b16 v[206:207], v10 offset:25088
    s_waitcnt lgkmcnt(12)
    v_mfma_f32_32x32x16_bf16 v[160:175], v[236:239], v[32:35], v[160:175]
    ds_read_b64_tr_b16 v[236:237], v11 offset:24576
    ds_read_b64_tr_b16 v[238:239], v11 offset:25088
    buffer_load_dwordx4 v[84:87], v1, s[12:15], s33 offen offset:1024 sc1
    s_waitcnt lgkmcnt(12)
    v_mfma_f32_32x32x16_bf16 v[176:191], v[240:243], v[32:35], v[176:191]
    ds_read_b64_tr_b16 v[240:241], v10 offset:25600
    ds_read_b64_tr_b16 v[242:243], v10 offset:26112
    s_waitcnt vmcnt(12)
    s_waitcnt lgkmcnt(12)
    v_mfma_f32_32x32x16_bf16 v[128:143], v[244:247], v[36:39], v[128:143]
    ds_read_b64_tr_b16 v[244:245], v11 offset:25600
    ds_read_b64_tr_b16 v[246:247], v11 offset:26112
    buffer_load_dwordx4 v[88:91], v1, s[12:15], s33 offen offset:2048 sc1
    s_waitcnt lgkmcnt(12)
    v_mfma_f32_32x32x16_bf16 v[144:159], v[192:195], v[36:39], v[144:159]
    ds_read_b64_tr_b16 v[192:193], v10 offset:26624
    ds_read_b64_tr_b16 v[194:195], v10 offset:27136
    s_waitcnt lgkmcnt(12)
    v_mfma_f32_32x32x16_bf16 v[160:175], v[196:199], v[36:39], v[160:175]
    ds_read_b64_tr_b16 v[196:197], v11 offset:26624
    ds_read_b64_tr_b16 v[198:199], v11 offset:27136
    buffer_load_dwordx4 v[92:95], v1, s[12:15], s33 offen offset:3072 sc1
    s_waitcnt lgkmcnt(12)
    v_mfma_f32_32x32x16_bf16 v[176:191], v[200:203], v[36:39], v[176:191]
    ds_read_b64_tr_b16 v[200:201], v10 offset:27648
    ds_read_b64_tr_b16 v[202:203], v10 offset:28160
    s_waitcnt vmcnt(13)
    s_waitcnt lgkmcnt(12)
    v_mfma_f32_32x32x16_bf16 v[128:143], v[204:207], v[40:43], v[128:143]
    ds_read_b64_tr_b16 v[204:205], v11 offset:27648
    ds_read_b64_tr_b16 v[206:207], v11 offset:28160
    s_add_u32 s18, s18, 1
    s_cmp_eq_u32 s18, 7
    s_cselect_b32 s25, -6, 1
    s_lshl_b32 s25, s25, 12
    s_add_u32 s33, s33, s25
    buffer_load_dwordx4 v[96:99], v1, s[12:15], s33 offen offset:0 sc1
    s_waitcnt lgkmcnt(12)
    v_mfma_f32_32x32x16_bf16 v[144:159], v[236:239], v[40:43], v[144:159]
    ds_read_b64_tr_b16 v[236:237], v10 offset:32768
    ds_read_b64_tr_b16 v[238:239], v10 offset:33280
    s_waitcnt lgkmcnt(12)
    v_mfma_f32_32x32x16_bf16 v[160:175], v[240:243], v[40:43], v[160:175]
    ds_read_b64_tr_b16 v[240:241], v11 offset:32768
    ds_read_b64_tr_b16 v[242:243], v11 offset:33280
    buffer_load_dwordx4 v[100:103], v1, s[12:15], s33 offen offset:1024 sc1
    s_waitcnt lgkmcnt(12)
    v_mfma_f32_32x32x16_bf16 v[176:191], v[244:247], v[40:43], v[176:191]
    ds_read_b64_tr_b16 v[244:245], v10 offset:33792
    ds_read_b64_tr_b16 v[246:247], v10 offset:34304
    s_waitcnt vmcnt(14)
    s_waitcnt lgkmcnt(12)
    v_mfma_f32_32x32x16_bf16 v[128:143], v[192:195], v[44:47], v[128:143]
    ds_read_b64_tr_b16 v[192:193], v11 offset:33792
    ds_read_b64_tr_b16 v[194:195], v11 offset:34304
    buffer_load_dwordx4 v[104:107], v1, s[12:15], s33 offen offset:2048 sc1
    s_waitcnt lgkmcnt(12)
    v_mfma_f32_32x32x16_bf16 v[144:159], v[196:199], v[44:47], v[144:159]
    ds_read_b64_tr_b16 v[196:197], v10 offset:34816
    ds_read_b64_tr_b16 v[198:199], v10 offset:35328
    s_waitcnt lgkmcnt(12)
    v_mfma_f32_32x32x16_bf16 v[160:175], v[200:203], v[44:47], v[160:175]
    ds_read_b64_tr_b16 v[200:201], v11 offset:34816
    ds_read_b64_tr_b16 v[202:203], v11 offset:35328
    buffer_load_dwordx4 v[108:111], v1, s[12:15], s33 offen offset:3072 sc1
    s_waitcnt lgkmcnt(12)
    v_mfma_f32_32x32x16_bf16 v[176:191], v[204:207], v[44:47], v[176:191]
    ds_read_b64_tr_b16 v[204:205], v10 offset:35840
    ds_read_b64_tr_b16 v[206:207], v10 offset:36352
    s_waitcnt vmcnt(12)
    s_waitcnt lgkmcnt(12)
    v_mfma_f32_32x32x16_bf16 v[128:143], v[236:239], v[48:51], v[128:143]
    ds_read_b64_tr_b16 v[236:237], v11 offset:35840
    ds_read_b64_tr_b16 v[238:239], v11 offset:36352
    s_add_u32 s18, s18, 1
    s_cmp_eq_u32 s18, 7
    s_cselect_b32 s25, -6, 1
    s_lshl_b32 s25, s25, 12
    s_add_u32 s33, s33, s25
    buffer_load_dwordx4 v[112:115], v1, s[12:15], s33 offen offset:0 sc1
    s_waitcnt lgkmcnt(12)
    v_mfma_f32_32x32x16_bf16 v[144:159], v[240:243], v[48:51], v[144:159]
    ds_read_b64_tr_b16 v[240:241], v10 offset:40960
    ds_read_b64_tr_b16 v[242:243], v10 offset:41472
    s_waitcnt lgkmcnt(12)
    v_mfma_f32_32x32x16_bf16 v[160:175], v[244:247], v[48:51], v[160:175]
    ds_read_b64_tr_b16 v[244:245], v11 offset:40960
    ds_read_b64_tr_b16 v[246:247], v11 offset:41472
    buffer_load_dwordx4 v[116:119], v1, s[12:15], s33 offen offset:1024 sc1
    s_waitcnt lgkmcnt(12)
    v_mfma_f32_32x32x16_bf16 v[176:191], v[192:195], v[48:51], v[176:191]
    ds_read_b64_tr_b16 v[192:193], v10 offset:41984
    ds_read_b64_tr_b16 v[194:195], v10 offset:42496
    s_waitcnt lgkmcnt(12)
    v_mfma_f32_32x32x16_bf16 v[128:143], v[196:199], v[52:55], v[128:143]
    ds_read_b64_tr_b16 v[196:197], v11 offset:41984
    ds_read_b64_tr_b16 v[198:199], v11 offset:42496
    buffer_load_dwordx4 v[120:123], v1, s[12:15], s33 offen offset:2048 sc1
    s_waitcnt lgkmcnt(12)
    v_mfma_f32_32x32x16_bf16 v[144:159], v[200:203], v[52:55], v[144:159]
    ds_read_b64_tr_b16 v[200:201], v10 offset:43008
    ds_read_b64_tr_b16 v[202:203], v10 offset:43520
    s_waitcnt lgkmcnt(12)
    v_mfma_f32_32x32x16_bf16 v[160:175], v[204:207], v[52:55], v[160:175]
    ds_read_b64_tr_b16 v[204:205], v11 offset:43008
    ds_read_b64_tr_b16 v[206:207], v11 offset:43520
    buffer_load_dwordx4 v[124:127], v1, s[12:15], s33 offen offset:3072 sc1
    s_waitcnt lgkmcnt(12)
    v_mfma_f32_32x32x16_bf16 v[176:191], v[236:239], v[52:55], v[176:191]
    ds_read_b64_tr_b16 v[236:237], v10 offset:44032
    ds_read_b64_tr_b16 v[238:239], v10 offset:44544
    s_waitcnt lgkmcnt(12)
    v_mfma_f32_32x32x16_bf16 v[128:143], v[240:243], v[56:59], v[128:143]
    ds_read_b64_tr_b16 v[240:241], v11 offset:44032
    ds_read_b64_tr_b16 v[242:243], v11 offset:44544
    s_waitcnt lgkmcnt(12)
    v_mfma_f32_32x32x16_bf16 v[144:159], v[244:247], v[56:59], v[144:159]
    ds_read_b64_tr_b16 v[244:245], v10 offset:49152
    ds_read_b64_tr_b16 v[246:247], v10 offset:49664
    s_waitcnt lgkmcnt(12)
    v_mfma_f32_32x32x16_bf16 v[160:175], v[192:195], v[56:59], v[160:175]
    ds_read_b64_tr_b16 v[192:193], v11 offset:49152
    ds_read_b64_tr_b16 v[194:195], v11 offset:49664
    buffer_load_dwordx2 v[208:209], v4, s[12:15], s23 offen offset:0 sc1
    s_waitcnt lgkmcnt(12)
    v_mfma_f32_32x32x16_bf16 v[176:191], v[196:199], v[56:59], v[176:191]
    ds_read_b64_tr_b16 v[196:197], v10 offset:50176
    ds_read_b64_tr_b16 v[198:199], v10 offset:50688
    buffer_load_dwordx2 v[210:211], v4, s[12:15], s23 offen offset:256 sc1
    s_waitcnt lgkmcnt(12)
    v_mfma_f32_32x32x16_bf16 v[128:143], v[200:203], v[60:63], v[128:143]
    ds_read_b64_tr_b16 v[200:201], v11 offset:50176
    ds_read_b64_tr_b16 v[202:203], v11 offset:50688
    buffer_load_dwordx2 v[212:213], v4, s[12:15], s23 offen offset:512 sc1
    s_waitcnt lgkmcnt(12)
    v_mfma_f32_32x32x16_bf16 v[144:159], v[204:207], v[60:63], v[144:159]
    ds_read_b64_tr_b16 v[204:205], v10 offset:51200
    ds_read_b64_tr_b16 v[206:207], v10 offset:51712
    buffer_load_dwordx2 v[214:215], v4, s[12:15], s23 offen offset:768 sc1
    s_waitcnt lgkmcnt(12)
    v_mfma_f32_32x32x16_bf16 v[160:175], v[236:239], v[60:63], v[160:175]
    ds_read_b64_tr_b16 v[236:237], v11 offset:51200
    ds_read_b64_tr_b16 v[238:239], v11 offset:51712
    buffer_load_dwordx2 v[216:217], v4, s[12:15], s23 offen offset:1024 sc1
    s_waitcnt lgkmcnt(12)
    v_mfma_f32_32x32x16_bf16 v[176:191], v[240:243], v[60:63], v[176:191]
    ds_read_b64_tr_b16 v[240:241], v10 offset:52224
    ds_read_b64_tr_b16 v[242:243], v10 offset:52736
    buffer_load_dwordx2 v[218:219], v4, s[12:15], s23 offen offset:1280 sc1
    s_waitcnt vmcnt(18)
    s_waitcnt lgkmcnt(12)
    v_mfma_f32_32x32x16_bf16 v[128:143], v[244:247], v[64:67], v[128:143]
    ds_read_b64_tr_b16 v[244:245], v11 offset:52224
    ds_read_b64_tr_b16 v[246:247], v11 offset:52736
    buffer_load_dwordx2 v[220:221], v4, s[12:15], s23 offen offset:1536 sc1
    s_waitcnt lgkmcnt(12)
    v_mfma_f32_32x32x16_bf16 v[144:159], v[192:195], v[64:67], v[144:159]
    ds_read_b64_tr_b16 v[192:193], v10 offset:57344
    ds_read_b64_tr_b16 v[194:195], v10 offset:57856
    buffer_load_dword v224, v2, s[12:15], s24 offen offset:0 sc1
    s_waitcnt lgkmcnt(12)
    v_mfma_f32_32x32x16_bf16 v[160:175], v[196:199], v[64:67], v[160:175]
    ds_read_b64_tr_b16 v[196:197], v11 offset:57344
    ds_read_b64_tr_b16 v[198:199], v11 offset:57856
    buffer_load_dword v225, v2, s[12:15], s24 offen offset:128 sc1
    s_waitcnt lgkmcnt(12)
    v_mfma_f32_32x32x16_bf16 v[176:191], v[200:203], v[64:67], v[176:191]
    ds_read_b64_tr_b16 v[200:201], v10 offset:58368
    ds_read_b64_tr_b16 v[202:203], v10 offset:58880
    buffer_load_dword v226, v2, s[12:15], s28 offen offset:0 sc1
    s_waitcnt lgkmcnt(12)
    v_mfma_f32_32x32x16_bf16 v[128:143], v[204:207], v[68:71], v[128:143]
    ds_read_b64_tr_b16 v[204:205], v11 offset:58368
    ds_read_b64_tr_b16 v[206:207], v11 offset:58880
    buffer_load_dword v227, v2, s[12:15], s28 offen offset:128 sc1
    s_waitcnt lgkmcnt(12)
    v_mfma_f32_32x32x16_bf16 v[144:159], v[236:239], v[68:71], v[144:159]
    ds_read_b64_tr_b16 v[236:237], v10 offset:59392
    ds_read_b64_tr_b16 v[238:239], v10 offset:59904
    s_waitcnt lgkmcnt(12)
    v_mfma_f32_32x32x16_bf16 v[160:175], v[240:243], v[68:71], v[160:175]
    ds_read_b64_tr_b16 v[240:241], v11 offset:59392
    ds_read_b64_tr_b16 v[242:243], v11 offset:59904
    s_lshl_b32 s25, s20, 11
    s_add_u32 m0, s25, 114688
    s_nop 0
    buffer_load_dwordx4 v14, s[64:67], s36 offen lds
    buffer_load_dwordx4 v15, s[64:67], s36 offen offset:1024 lds
    s_waitcnt lgkmcnt(12)
    v_mfma_f32_32x32x16_bf16 v[176:191], v[244:247], v[68:71], v[176:191]
    ds_read_b64_tr_b16 v[244:245], v10 offset:60416
    ds_read_b64_tr_b16 v[246:247], v10 offset:60928
    s_waitcnt lgkmcnt(12)
    v_mfma_f32_32x32x16_bf16 v[128:143], v[192:195], v[72:75], v[128:143]
    ds_read_b64_tr_b16 v[192:193], v11 offset:60416
    ds_read_b64_tr_b16 v[194:195], v11 offset:60928
    s_waitcnt lgkmcnt(12)
    v_mfma_f32_32x32x16_bf16 v[144:159], v[196:199], v[72:75], v[144:159]
    ds_read_b64_tr_b16 v[196:197], v12 offset:0
    ds_read_b64_tr_b16 v[198:199], v12 offset:512
    s_waitcnt lgkmcnt(12)
    v_mfma_f32_32x32x16_bf16 v[160:175], v[200:203], v[72:75], v[160:175]
    ds_read_b64_tr_b16 v[200:201], v12 offset:1024
    ds_read_b64_tr_b16 v[202:203], v12 offset:1536
    s_lshl_b32 s25, s20, 11
    s_add_u32 m0, s25, 131072
    s_add_u32 s35, s35, 1
    s_cmp_eq_u32 s35, 14
    s_cselect_b32 s25, -13, 1
    s_mul_i32 s25, s25, 28672
    s_add_u32 s36, s36, s25
    buffer_load_dwordx4 v14, s[64:67], s36 offen lds
    buffer_load_dwordx4 v15, s[64:67], s36 offen offset:1024 lds
    s_waitcnt lgkmcnt(12)
    v_mfma_f32_32x32x16_bf16 v[176:191], v[204:207], v[72:75], v[176:191]
    ds_read_b64_tr_b16 v[204:205], v12 offset:2048
    ds_read_b64_tr_b16 v[206:207], v12 offset:2560
    s_waitcnt lgkmcnt(12)
    v_mfma_f32_32x32x16_bf16 v[128:143], v[236:239], v[76:79], v[128:143]
    s_waitcnt lgkmcnt(10)
    v_mfma_f32_32x32x16_bf16 v[144:159], v[240:243], v[76:79], v[144:159]
    s_waitcnt lgkmcnt(8)
    v_mfma_f32_32x32x16_bf16 v[160:175], v[244:247], v[76:79], v[160:175]
    s_lshl_b32 s25, s20, 11
    s_add_u32 m0, s25, 147456
    s_add_u32 s35, s35, 1
    s_cmp_eq_u32 s35, 14
    s_cselect_b32 s25, -13, 1
    s_mul_i32 s25, s25, 28672
    s_add_u32 s36, s36, s25
    buffer_load_dwordx4 v14, s[64:67], s36 offen lds
    buffer_load_dwordx4 v15, s[64:67], s36 offen offset:1024 lds
    s_waitcnt lgkmcnt(6)
    v_mfma_f32_32x32x16_bf16 v[176:191], v[192:195], v[76:79], v[176:191]
    ds_read_b64_tr_b16 v[192:193], v12 offset:3072
    ds_read_b64_tr_b16 v[194:195], v12 offset:3584
    s_waitcnt vmcnt(25)
    s_waitcnt lgkmcnt(6)
    v_mfma_f32_32x32x16_bf16 v[128:143], v[196:199], v[80:83], v[128:143]
    ds_read_b64_tr_b16 v[196:197], v12 offset:8192
    ds_read_b64_tr_b16 v[198:199], v12 offset:8704
    s_waitcnt lgkmcnt(6)
    v_mfma_f32_32x32x16_bf16 v[160:175], v[200:203], v[80:83], v[160:175]
    ds_read_b64_tr_b16 v[200:201], v12 offset:9216
    ds_read_b64_tr_b16 v[202:203], v12 offset:9728
    s_waitcnt lgkmcnt(6)
    v_mfma_f32_32x32x16_bf16 v[128:143], v[204:207], v[84:87], v[128:143]
    ds_read_b64_tr_b16 v[204:205], v12 offset:10240
    ds_read_b64_tr_b16 v[206:207], v12 offset:10752
    s_waitcnt lgkmcnt(6)
    v_mfma_f32_32x32x16_bf16 v[160:175], v[192:195], v[84:87], v[160:175]
    ds_read_b64_tr_b16 v[192:193], v12 offset:11264
    ds_read_b64_tr_b16 v[194:195], v12 offset:11776
    s_waitcnt lgkmcnt(6)
    v_mfma_f32_32x32x16_bf16 v[128:143], v[196:199], v[88:91], v[128:143]
    ds_read_b64_tr_b16 v[196:197], v12 offset:16384
    ds_read_b64_tr_b16 v[198:199], v12 offset:16896
    s_waitcnt lgkmcnt(6)
    v_mfma_f32_32x32x16_bf16 v[160:175], v[200:203], v[88:91], v[160:175]
    ds_read_b64_tr_b16 v[200:201], v12 offset:17408
    ds_read_b64_tr_b16 v[202:203], v12 offset:17920
    s_waitcnt lgkmcnt(6)
    v_mfma_f32_32x32x16_bf16 v[128:143], v[204:207], v[92:95], v[128:143]
    ds_read_b64_tr_b16 v[204:205], v12 offset:18432
    ds_read_b64_tr_b16 v[206:207], v12 offset:18944
    s_waitcnt lgkmcnt(6)
    v_mfma_f32_32x32x16_bf16 v[160:175], v[192:195], v[92:95], v[160:175]
    ds_read_b64_tr_b16 v[192:193], v12 offset:19456
    ds_read_b64_tr_b16 v[194:195], v12 offset:19968
    s_waitcnt vmcnt(6)
    s_mov_b32 s72, 0x100000
Lkf_csw:
    v_max_u32 v228, v224, v225
    v_max3_u32 v228, v228, v226, v227
    v_cmp_eq_u32 vcc, -1, v228
    s_cbranch_vccz Lkf_cswok
    s_sleep 4
    buffer_load_dword v224, v2, s[12:15], s24 offen offset:0 sc1
    buffer_load_dword v225, v2, s[12:15], s24 offen offset:128 sc1
    buffer_load_dword v226, v2, s[12:15], s28 offen offset:0 sc1
    buffer_load_dword v227, v2, s[12:15], s28 offen offset:128 sc1
    s_waitcnt vmcnt(0)
    s_sub_u32 s72, s72, 1
    s_cbranch_scc0 Lkf_csw
Lkf_cswok:
    v_add_f32 v208, v208, v210
    v_add_f32 v209, v209, v211
    v_add_f32 v208, v208, v212
    v_add_f32 v209, v209, v213
    s_waitcnt vmcnt(21)
    s_waitcnt lgkmcnt(6)
    v_mfma_f32_32x32x16_bf16 v[128:143], v[196:199], v[96:99], v[128:143]
    ds_read_b64_tr_b16 v[196:197], v12 offset:24576
    ds_read_b64_tr_b16 v[198:199], v12 offset:25088
    v_add_f32 v208, v208, v214
    v_add_f32 v209, v209, v215
    v_add_f32 v208, v208, v216
    v_add_f32 v209, v209, v217
    s_waitcnt lgkmcnt(6)
    v_mfma_f32_32x32x16_bf16 v[160:175], v[200:203], v[96:99], v[160:175]
    ds_read_b64_tr_b16 v[200:201], v12 offset:25600
    ds_read_b64_tr_b16 v[202:203], v12 offset:26112
    v_add_f32 v208, v208, v218
    v_add_f32 v209, v209, v219
    v_add_f32 v208, v208, v220
    v_add_f32 v209, v209, v221
    s_waitcnt lgkmcnt(6)
    v_mfma_f32_32x32x16_bf16 v[128:143], v[204:207], v[100:103], v[128:143]
    ds_read_b64_tr_b16 v[204:205], v12 offset:26624
    ds_read_b64_tr_b16 v[206:207], v12 offset:27136
    v_cmp_eq_u32 vcc, 0, v9
    v_mov_b32 v210, v208
    v_mov_b32 v211, v209
    v_cndmask_b32 v224, 0, v224, vcc
    s_waitcnt lgkmcnt(6)
    v_mfma_f32_32x32x16_bf16 v[160:175], v[192:195], v[100:103], v[160:175]
    ds_read_b64_tr_b16 v[192:193], v12 offset:27648
    ds_read_b64_tr_b16 v[194:195], v12 offset:28160
    v_cndmask_b32 v225, 0, v225, vcc
    v_permlane32_swap_b32 v208, v210
    v_permlane32_swap_b32 v209, v211
    v_cndmask_b32 v226, 0, v226, vcc
    s_waitcnt lgkmcnt(6)
    v_mfma_f32_32x32x16_bf16 v[128:143], v[196:199], v[104:107], v[128:143]
    s_waitcnt vmcnt(45)
    s_barrier
    ds_read_b64_tr_b16 v[196:197], v12 offset:32768
    ds_read_b64_tr_b16 v[198:199], v12 offset:33280
    v_cndmask_b32 v227, 0, v227, vcc
    v_add_f32 v208, v208, v210
    v_add_f32 v209, v209, v211
    v_mul_f32 v208, 0xbb124925, v208
    s_waitcnt lgkmcnt(6)
    v_mfma_f32_32x32x16_bf16 v[160:175], v[200:203], v[104:107], v[160:175]
    ds_read_b64_tr_b16 v[200:201], v12 offset:33792
    ds_read_b64_tr_b16 v[202:203], v12 offset:34304
    v_mul_f32 v209, 0x3b124925, v209
    v_fma_f32 v209, -v208, v208, v209
    v_max_f32 v209, 0, v209
    v_add_f32 v210, 0x3727c5ac, v209
    s_waitcnt lgkmcnt(6)
    v_mfma_f32_32x32x16_bf16 v[128:143], v[204:207], v[108:111], v[128:143]
    ds_read_b64_tr_b16 v[204:205], v12 offset:34816
    ds_read_b64_tr_b16 v[206:207], v12 offset:35328
    s_lshl_b32 s25, s20, 11
    s_add_u32 m0, s25, 0
    s_add_u32 s35, s35, 1
    s_cmp_eq_u32 s35, 14
    s_cselect_b32 s25, -13, 1
    s_mul_i32 s25, s25, 28672
    s_add_u32 s36, s36, s25
    buffer_load_dwordx4 v14, s[64:67], s36 offen lds
    buffer_load_dwordx4 v15, s[64:67], s36 offen offset:1024 lds
    v_rsq_f32 v212, v210
    v_cvt_pk_bf16_f32 v232, v208, v208
    v_and_b32 v228, 0xffff0000, v232
    v_sub_f32 v228, v208, v228
    s_waitcnt lgkmcnt(6)
    v_mfma_f32_32x32x16_bf16 v[160:175], v[192:195], v[108:111], v[160:175]
    ds_read_b64_tr_b16 v[192:193], v12 offset:35840
    ds_read_b64_tr_b16 v[194:195], v12 offset:36352
    v_cvt_pk_bf16_f32 v233, v228, 0
    v_mov_b32 v234, 0
    v_mov_b32 v235, 0
    v_mul_f32 v212, 0xbfb8aa3b, v212
    s_waitcnt vmcnt(19)
    s_waitcnt lgkmcnt(6)
    v_mfma_f32_32x32x16_bf16 v[128:143], v[196:199], v[112:115], v[128:143]
    ds_read_b64_tr_b16 v[196:197], v12 offset:40960
    ds_read_b64_tr_b16 v[198:199], v12 offset:41472
    v_cvt_pk_bf16_f32 v237, v224, 0
    v_mov_b32 v238, 0
    v_lshlrev_b32 v229, 16, v237
    v_sub_f32 v229, v224, v229
    s_waitcnt lgkmcnt(6)
    v_mfma_f32_32x32x16_bf16 v[160:175], v[200:203], v[112:115], v[160:175]
    ds_read_b64_tr_b16 v[200:201], v12 offset:41984
    ds_read_b64_tr_b16 v[202:203], v12 offset:42496
    v_mov_b32 v239, 0
    v_cvt_pk_bf16_f32 v236, v224, v229
    v_cvt_pk_bf16_f32 v241, v225, 0
    v_mov_b32 v242, 0
    s_waitcnt lgkmcnt(6)
    v_mfma_f32_32x32x16_bf16 v[128:143], v[204:207], v[116:119], v[128:143]
    ds_read_b64_tr_b16 v[204:205], v12 offset:43008
    ds_read_b64_tr_b16 v[206:207], v12 offset:43520
    v_lshlrev_b32 v229, 16, v241
    v_sub_f32 v229, v225, v229
    v_mov_b32 v243, 0
    v_cvt_pk_bf16_f32 v240, v225, v229
    s_waitcnt lgkmcnt(6)
    v_mfma_f32_32x32x16_bf16 v[160:175], v[192:195], v[116:119], v[160:175]
    ds_read_b64_tr_b16 v[192:193], v12 offset:44032
    ds_read_b64_tr_b16 v[194:195], v12 offset:44544
    s_lshl_b32 s25, s20, 11
    s_add_u32 m0, s25, 16384
    s_add_u32 s35, s35, 1
    s_cmp_eq_u32 s35, 14
    s_cselect_b32 s25, -13, 1
    s_mul_i32 s25, s25, 28672
    s_add_u32 s36, s36, s25
    buffer_load_dwordx4 v14, s[64:67], s36 offen lds
    buffer_load_dwordx4 v15, s[64:67], s36 offen offset:1024 lds
    v_cvt_pk_bf16_f32 v245, v226, 0
    v_mov_b32 v246, 0
    v_lshlrev_b32 v229, 16, v245
    v_sub_f32 v229, v226, v229
    s_waitcnt lgkmcnt(6)
    v_mfma_f32_32x32x16_bf16 v[128:143], v[196:199], v[120:123], v[128:143]
    ds_read_b64_tr_b16 v[196:197], v13 offset:0
    ds_read_b64_tr_b16 v[198:199], v13 offset:512
    v_mov_b32 v247, 0
    v_cvt_pk_bf16_f32 v244, v226, v229
    v_cvt_pk_bf16_f32 v249, v227, 0
    v_mov_b32 v250, 0
    s_waitcnt lgkmcnt(6)
    v_mfma_f32_32x32x16_bf16 v[160:175], v[200:203], v[120:123], v[160:175]
    ds_read_b64_tr_b16 v[200:201], v13 offset:1024
    ds_read_b64_tr_b16 v[202:203], v13 offset:1536
    v_lshlrev_b32 v229, 16, v249
    v_sub_f32 v229, v227, v229
    v_mov_b32 v251, 0
    v_cvt_pk_bf16_f32 v248, v227, v229
    s_waitcnt lgkmcnt(6)
    v_mfma_f32_32x32x16_bf16 v[128:143], v[204:207], v[124:127], v[128:143]
    ds_read_b64_tr_b16 v[204:205], v13 offset:2048
    ds_read_b64_tr_b16 v[206:207], v13 offset:2560
    s_mul_i32 s23, s17, 114688
    s_lshl_b32 s24, s16, 12
    s_add_u32 s23, s23, s24
    s_add_u32 s23, s23, 4243456
    s_waitcnt lgkmcnt(6)
    v_mfma_f32_32x32x16_bf16 v[160:175], v[192:195], v[124:127], v[160:175]
    ds_read_b64_tr_b16 v[192:193], v13 offset:3072
    ds_read_b64_tr_b16 v[194:195], v13 offset:3584
    v_mfma_f32_32x32x16_bf16 v[128:143], v[236:239], v[232:235], v[128:143]
    s_lshl_b32 s25, s20, 11
    s_add_u32 m0, s25, 32768
    s_add_u32 s35, s35, 1
    s_cmp_eq_u32 s35, 14
    s_cselect_b32 s25, -13, 1
    s_mul_i32 s25, s25, 28672
    s_add_u32 s36, s36, s25
    buffer_load_dwordx4 v14, s[64:67], s36 offen lds
    buffer_load_dwordx4 v15, s[64:67], s36 offen offset:1024 lds
    v_mfma_f32_32x32x16_bf16 v[160:175], v[244:247], v[232:235], v[160:175]
    s_waitcnt lgkmcnt(6)
    v_mfma_f32_32x32x16_bf16 v[144:159], v[196:199], v[80:83], v[144:159]
    ds_read_b64_tr_b16 v[196:197], v13 offset:8192
    ds_read_b64_tr_b16 v[198:199], v13 offset:8704
    s_waitcnt lgkmcnt(6)
    v_mfma_f32_32x32x16_bf16 v[176:191], v[200:203], v[80:83], v[176:191]
    ds_read_b64_tr_b16 v[200:201], v13 offset:9216
    ds_read_b64_tr_b16 v[202:203], v13 offset:9728
    s_waitcnt lgkmcnt(6)
    v_mfma_f32_32x32x16_bf16 v[144:159], v[204:207], v[84:87], v[144:159]
    ds_read_b64_tr_b16 v[204:205], v13 offset:10240
    ds_read_b64_tr_b16 v[206:207], v13 offset:10752
    s_waitcnt lgkmcnt(6)
    v_mfma_f32_32x32x16_bf16 v[176:191], v[192:195], v[84:87], v[176:191]
    ds_read_b64_tr_b16 v[192:193], v13 offset:11264
    ds_read_b64_tr_b16 v[194:195], v13 offset:11776
    s_lshl_b32 s25, s20, 11
    s_add_u32 m0, s25, 49152
    s_add_u32 s35, s35, 1
    s_cmp_eq_u32 s35, 14
    s_cselect_b32 s25, -13, 1
    s_mul_i32 s25, s25, 28672
    s_add_u32 s36, s36, s25
    buffer_load_dwordx4 v14, s[64:67], s36 offen lds
    buffer_load_dwordx4 v15, s[64:67], s36 offen offset:1024 lds
    v_mul_f32 v32, v128, v212
    v_mul_f32 v33, v129, v212
    v_exp_f32 v32, v32
    v_mul_f32 v128, v128, v160
    v_exp_f32 v33, v33
    s_waitcnt lgkmcnt(6)
    v_mfma_f32_32x32x16_bf16 v[144:159], v[196:199], v[88:91], v[144:159]
    ds_read_b64_tr_b16 v[196:197], v13 offset:16384
    ds_read_b64_tr_b16 v[198:199], v13 offset:16896
    v_mul_f32 v129, v129, v161
    v_fma_f32 v32, v32, v210, v210
    v_fma_f32 v33, v33, v210, v210
    v_rcp_f32 v32, v32
    v_rcp_f32 v33, v33
    s_waitcnt lgkmcnt(6)
    v_mfma_f32_32x32x16_bf16 v[176:191], v[200:203], v[88:91], v[176:191]
    ds_read_b64_tr_b16 v[200:201], v13 offset:17408
    ds_read_b64_tr_b16 v[202:203], v13 offset:17920
    v_mul_f32 v128, v128, v32
    v_mul_f32 v129, v129, v33
    v_cvt_pk_bf16_f32 v16, v128, v129
    v_mul_f32 v34, v130, v212
    v_mul_f32 v35, v131, v212
    s_waitcnt lgkmcnt(6)
    v_mfma_f32_32x32x16_bf16 v[144:159], v[204:207], v[92:95], v[144:159]
    ds_read_b64_tr_b16 v[204:205], v13 offset:18432
    ds_read_b64_tr_b16 v[206:207], v13 offset:18944
    v_exp_f32 v34, v34
    v_mul_f32 v130, v130, v162
    v_exp_f32 v35, v35
    v_mul_f32 v131, v131, v163
    v_fma_f32 v34, v34, v210, v210
    s_waitcnt lgkmcnt(6)
    v_mfma_f32_32x32x16_bf16 v[176:191], v[192:195], v[92:95], v[176:191]
    ds_read_b64_tr_b16 v[192:193], v13 offset:19456
    ds_read_b64_tr_b16 v[194:195], v13 offset:19968
    v_fma_f32 v35, v35, v210, v210
    v_rcp_f32 v34, v34
    v_rcp_f32 v35, v35
    v_mul_f32 v130, v130, v34
    v_mul_f32 v131, v131, v35
    s_waitcnt lgkmcnt(6)
    v_mfma_f32_32x32x16_bf16 v[144:159], v[196:199], v[96:99], v[144:159]
    ds_read_b64_tr_b16 v[196:197], v13 offset:24576
    ds_read_b64_tr_b16 v[198:199], v13 offset:25088
    s_add_u32 s19, s31, 10
    s_cmp_ge_u32 s19, 14
    s_cselect_b32 s25, 14, 0
    s_sub_u32 s19, s19, s25
    s_mul_i32 s19, s19, 28672
    s_add_u32 s19, s19, s30
    buffer_load_dwordx4 v[40:43], v14, s[64:67], s19 offen offset:0
    v_cvt_pk_bf16_f32 v17, v130, v131
    v_mul_f32 v36, v132, v212
    v_mul_f32 v37, v133, v212
    v_exp_f32 v36, v36
    v_mul_f32 v132, v132, v164
    s_waitcnt lgkmcnt(6)
    v_mfma_f32_32x32x16_bf16 v[176:191], v[200:203], v[96:99], v[176:191]
    ds_read_b64_tr_b16 v[200:201], v13 offset:25600
    ds_read_b64_tr_b16 v[202:203], v13 offset:26112
    v_exp_f32 v37, v37
    v_mul_f32 v133, v133, v165
    v_fma_f32 v36, v36, v210, v210
    v_fma_f32 v37, v37, v210, v210
    v_rcp_f32 v36, v36
    s_waitcnt lgkmcnt(6)
    v_mfma_f32_32x32x16_bf16 v[144:159], v[204:207], v[100:103], v[144:159]
    ds_read_b64_tr_b16 v[204:205], v13 offset:26624
    ds_read_b64_tr_b16 v[206:207], v13 offset:27136
    buffer_load_dwordx4 v[44:47], v15, s[64:67], s19 offen offset:1024
    v_rcp_f32 v37, v37
    v_mul_f32 v132, v132, v36
    v_mul_f32 v133, v133, v37
    v_cvt_pk_bf16_f32 v18, v132, v133
    v_mul_f32 v38, v134, v212
    s_waitcnt lgkmcnt(6)
    v_mfma_f32_32x32x16_bf16 v[176:191], v[192:195], v[100:103], v[176:191]
    ds_read_b64_tr_b16 v[192:193], v13 offset:27648
    ds_read_b64_tr_b16 v[194:195], v13 offset:28160
    v_mul_f32 v39, v135, v212
    v_exp_f32 v38, v38
    v_mul_f32 v134, v134, v166
    v_exp_f32 v39, v39
    v_mul_f32 v135, v135, v167
    s_waitcnt lgkmcnt(6)
    v_mfma_f32_32x32x16_bf16 v[144:159], v[196:199], v[104:107], v[144:159]
    ds_read_b64_tr_b16 v[196:197], v13 offset:32768
    ds_read_b64_tr_b16 v[198:199], v13 offset:33280
    s_add_u32 s19, s31, 11
    s_cmp_ge_u32 s19, 14
    s_cselect_b32 s25, 14, 0
    s_sub_u32 s19, s19, s25
    s_mul_i32 s19, s19, 28672
    s_add_u32 s19, s19, s30
    buffer_load_dwordx4 v[48:51], v14, s[64:67], s19 offen offset:0
    v_fma_f32 v38, v38, v210, v210
    v_fma_f32 v39, v39, v210, v210
    v_rcp_f32 v38, v38
    v_rcp_f32 v39, v39
    v_mul_f32 v134, v134, v38
    s_waitcnt lgkmcnt(6)
    v_mfma_f32_32x32x16_bf16 v[176:191], v[200:203], v[104:107], v[176:191]
    ds_read_b64_tr_b16 v[200:201], v13 offset:33792
    ds_read_b64_tr_b16 v[202:203], v13 offset:34304
    v_mul_f32 v135, v135, v39
    v_cvt_pk_bf16_f32 v19, v134, v135
    buffer_store_dwordx4 v[16:19], v1, s[12:15], s23 offen offset:0 sc1
    v_mul_f32 v32, v136, v212
    v_mul_f32 v33, v137, v212
    s_waitcnt lgkmcnt(6)
    v_mfma_f32_32x32x16_bf16 v[144:159], v[204:207], v[108:111], v[144:159]
    ds_read_b64_tr_b16 v[204:205], v13 offset:34816
    ds_read_b64_tr_b16 v[206:207], v13 offset:35328
    buffer_load_dwordx4 v[52:55], v15, s[64:67], s19 offen offset:1024
    v_exp_f32 v32, v32
    v_mul_f32 v136, v136, v168
    v_exp_f32 v33, v33
    v_mul_f32 v137, v137, v169
    v_fma_f32 v32, v32, v210, v210
    s_waitcnt lgkmcnt(6)
    v_mfma_f32_32x32x16_bf16 v[176:191], v[192:195], v[108:111], v[176:191]
    ds_read_b64_tr_b16 v[192:193], v13 offset:35840
    ds_read_b64_tr_b16 v[194:195], v13 offset:36352
    v_fma_f32 v33, v33, v210, v210
    v_rcp_f32 v32, v32
    v_rcp_f32 v33, v33
    v_mul_f32 v136, v136, v32
    v_mul_f32 v137, v137, v33
    s_waitcnt lgkmcnt(6)
    v_mfma_f32_32x32x16_bf16 v[144:159], v[196:199], v[112:115], v[144:159]
    ds_read_b64_tr_b16 v[196:197], v13 offset:40960
    ds_read_b64_tr_b16 v[198:199], v13 offset:41472
    s_add_u32 s19, s31, 12
    s_cmp_ge_u32 s19, 14
    s_cselect_b32 s25, 14, 0
    s_sub_u32 s19, s19, s25
    s_mul_i32 s19, s19, 28672
    s_add_u32 s19, s19, s30
    buffer_load_dwordx4 v[56:59], v14, s[64:67], s19 offen offset:0
    v_cvt_pk_bf16_f32 v20, v136, v137
    v_mul_f32 v34, v138, v212
    v_mul_f32 v35, v139, v212
    v_exp_f32 v34, v34
    v_mul_f32 v138, v138, v170
    s_waitcnt lgkmcnt(6)
    v_mfma_f32_32x32x16_bf16 v[176:191], v[200:203], v[112:115], v[176:191]
    ds_read_b64_tr_b16 v[200:201], v13 offset:41984
    ds_read_b64_tr_b16 v[202:203], v13 offset:42496
    v_exp_f32 v35, v35
    v_mul_f32 v139, v139, v171
    v_fma_f32 v34, v34, v210, v210
    v_fma_f32 v35, v35, v210, v210
    s_waitcnt lgkmcnt(6)
    v_mfma_f32_32x32x16_bf16 v[144:159], v[204:207], v[116:119], v[144:159]
    ds_read_b64_tr_b16 v[204:205], v13 offset:43008
    ds_read_b64_tr_b16 v[206:207], v13 offset:43520
    buffer_load_dwordx4 v[60:63], v15, s[64:67], s19 offen offset:1024
    v_rcp_f32 v34, v34
    v_rcp_f32 v35, v35
    v_mul_f32 v138, v138, v34
    v_mul_f32 v139, v139, v35
    s_waitcnt lgkmcnt(6)
    v_mfma_f32_32x32x16_bf16 v[176:191], v[192:195], v[116:119], v[176:191]
    ds_read_b64_tr_b16 v[192:193], v13 offset:44032
    ds_read_b64_tr_b16 v[194:195], v13 offset:44544
    v_cvt_pk_bf16_f32 v21, v138, v139
    v_mul_f32 v36, v140, v212
    v_mul_f32 v37, v141, v212
    v_exp_f32 v36, v36
    s_waitcnt lgkmcnt(6)
    v_mfma_f32_32x32x16_bf16 v[144:159], v[196:199], v[120:123], v[144:159]
    s_add_u32 s19, s31, 13
    s_cmp_ge_u32 s19, 14
    s_cselect_b32 s25, 14, 0
    s_sub_u32 s19, s19, s25
    s_mul_i32 s19, s19, 28672
    s_add_u32 s19, s19, s30
    buffer_load_dwordx4 v[64:67], v14, s[64:67], s19 offen offset:0
    v_mul_f32 v140, v140, v172
    v_exp_f32 v37, v37
    v_mul_f32 v141, v141, v173
    v_fma_f32 v36, v36, v210, v210
    s_waitcnt lgkmcnt(4)
    v_mfma_f32_32x32x16_bf16 v[176:191], v[200:203], v[120:123], v[176:191]
    v_fma_f32 v37, v37, v210, v210
    v_rcp_f32 v36, v36
    v_rcp_f32 v37, v37
    v_mul_f32 v140, v140, v36
    s_waitcnt lgkmcnt(2)
    v_mfma_f32_32x32x16_bf16 v[144:159], v[204:207], v[124:127], v[144:159]
    buffer_load_dwordx4 v[68:71], v15, s[64:67], s19 offen offset:1024
    v_mul_f32 v141, v141, v37
    v_cvt_pk_bf16_f32 v22, v140, v141
    v_mul_f32 v38, v142, v212
    v_mul_f32 v39, v143, v212
    s_waitcnt lgkmcnt(0)
    v_mfma_f32_32x32x16_bf16 v[176:191], v[192:195], v[124:127], v[176:191]
    v_exp_f32 v38, v38
    v_mul_f32 v142, v142, v174
    v_exp_f32 v39, v39
    v_mul_f32 v143, v143, v175
    v_mfma_f32_32x32x16_bf16 v[144:159], v[240:243], v[232:235], v[144:159]
    v_fma_f32 v38, v38, v210, v210
    v_fma_f32 v39, v39, v210, v210
    v_rcp_f32 v38, v38
    v_rcp_f32 v39, v39
    v_mfma_f32_32x32x16_bf16 v[176:191], v[248:251], v[232:235], v[176:191]
    v_mul_f32 v142, v142, v38
    v_mul_f32 v143, v143, v39
    v_cvt_pk_bf16_f32 v23, v142, v143
    buffer_store_dwordx4 v[20:23], v1, s[12:15], s23 offen offset:1024 sc1
    s_lshl_b32 s24, s29, 7
    s_add_u32 s24, s24, 11616256
    s_nop 9
    v_pk_mul_f32 v[32:33], v[144:145], v[212:213] op_sel_hi:[1,0]
    v_pk_mul_f32 v[144:145], v[144:145], v[176:177]
    v_exp_f32 v32, v32
    v_exp_f32 v33, v33
    s_nop 0
    v_pk_fma_f32 v[32:33], v[32:33], v[210:211], v[210:211] op_sel_hi:[1,0,0]
    v_rcp_f32 v32, v32
    v_rcp_f32 v33, v33
    s_nop 0
    v_pk_mul_f32 v[144:145], v[144:145], v[32:33]
    v_cvt_pk_bf16_f32 v24, v144, v145
    v_pk_mul_f32 v[34:35], v[146:147], v[212:213] op_sel_hi:[1,0]
    v_pk_mul_f32 v[146:147], v[146:147], v[178:179]
    v_exp_f32 v34, v34
    v_exp_f32 v35, v35
    s_nop 0
    v_pk_fma_f32 v[34:35], v[34:35], v[210:211], v[210:211] op_sel_hi:[1,0,0]
    v_rcp_f32 v34, v34
    v_rcp_f32 v35, v35
    s_nop 0
    v_pk_mul_f32 v[146:147], v[146:147], v[34:35]
    v_cvt_pk_bf16_f32 v25, v146, v147
    v_pk_mul_f32 v[36:37], v[148:149], v[212:213] op_sel_hi:[1,0]
    v_pk_mul_f32 v[148:149], v[148:149], v[180:181]
    v_exp_f32 v36, v36
    v_exp_f32 v37, v37
    s_nop 0
    v_pk_fma_f32 v[36:37], v[36:37], v[210:211], v[210:211] op_sel_hi:[1,0,0]
    v_rcp_f32 v36, v36
    v_rcp_f32 v37, v37
    s_nop 0
    v_pk_mul_f32 v[148:149], v[148:149], v[36:37]
    v_cvt_pk_bf16_f32 v26, v148, v149
    v_pk_mul_f32 v[38:39], v[150:151], v[212:213] op_sel_hi:[1,0]
    v_pk_mul_f32 v[150:151], v[150:151], v[182:183]
    v_exp_f32 v38, v38
    v_exp_f32 v39, v39
    s_nop 0
    v_pk_fma_f32 v[38:39], v[38:39], v[210:211], v[210:211] op_sel_hi:[1,0,0]
    v_rcp_f32 v38, v38
    v_rcp_f32 v39, v39
    s_nop 0
    v_pk_mul_f32 v[150:151], v[150:151], v[38:39]
    v_cvt_pk_bf16_f32 v27, v150, v151
    buffer_store_dwordx4 v[24:27], v1, s[12:15], s23 offen offset:2048 sc1
    v_pk_mul_f32 v[32:33], v[152:153], v[212:213] op_sel_hi:[1,0]
    v_pk_mul_f32 v[152:153], v[152:153], v[184:185]
    v_exp_f32 v32, v32
    v_exp_f32 v33, v33
    s_nop 0
    v_pk_fma_f32 v[32:33], v[32:33], v[210:211], v[210:211] op_sel_hi:[1,0,0]
    v_rcp_f32 v32, v32
    v_rcp_f32 v33, v33
    s_nop 0
    v_pk_mul_f32 v[152:153], v[152:153], v[32:33]
    v_cvt_pk_bf16_f32 v28, v152, v153
    v_pk_mul_f32 v[34:35], v[154:155], v[212:213] op_sel_hi:[1,0]
    v_pk_mul_f32 v[154:155], v[154:155], v[186:187]
    v_exp_f32 v34, v34
    v_exp_f32 v35, v35
    s_nop 0
    v_pk_fma_f32 v[34:35], v[34:35], v[210:211], v[210:211] op_sel_hi:[1,0,0]
    v_rcp_f32 v34, v34
    v_rcp_f32 v35, v35
    s_nop 0
    v_pk_mul_f32 v[154:155], v[154:155], v[34:35]
    v_cvt_pk_bf16_f32 v29, v154, v155
    v_pk_mul_f32 v[36:37], v[156:157], v[212:213] op_sel_hi:[1,0]
    v_pk_mul_f32 v[156:157], v[156:157], v[188:189]
    v_exp_f32 v36, v36
    v_exp_f32 v37, v37
    s_nop 0
    v_pk_fma_f32 v[36:37], v[36:37], v[210:211], v[210:211] op_sel_hi:[1,0,0]
    v_rcp_f32 v36, v36
    v_rcp_f32 v37, v37
    s_nop 0
    v_pk_mul_f32 v[156:157], v[156:157], v[36:37]
    v_cvt_pk_bf16_f32 v30, v156, v157
    v_pk_mul_f32 v[38:39], v[158:159], v[212:213] op_sel_hi:[1,0]
    v_pk_mul_f32 v[158:159], v[158:159], v[190:191]
    v_exp_f32 v38, v38
    v_exp_f32 v39, v39
    s_nop 0
    v_pk_fma_f32 v[38:39], v[38:39], v[210:211], v[210:211] op_sel_hi:[1,0,0]
    v_rcp_f32 v38, v38
    v_rcp_f32 v39, v39
    s_nop 0
    v_pk_mul_f32 v[158:159], v[158:159], v[38:39]
    v_cvt_pk_bf16_f32 v31, v158, v159
    buffer_store_dwordx4 v[28:31], v1, s[12:15], s23 offen offset:3072 sc1
    s_waitcnt vmcnt(0)
    s_barrier
    s_cmp_lg_u32 s20, 0
    s_cbranch_scc1 Lkf_sg2
    v_lshlrev_b32 v7, 7, v0
    v_mov_b32 v8, 1
    s_mov_b64 exec, 268435455
    buffer_atomic_add v8, v7, s[12:15], s24 offen sc1
    s_mov_b64 exec, -1
Lkf_sg2:
    s_lshl_b32 s25, s20, 11
    s_add_u32 m0, s25, 65536
    s_add_u32 s35, s35, 1
    s_cmp_eq_u32 s35, 14
    s_cselect_b32 s25, -13, 1
    s_mul_i32 s25, s25, 28672
    s_add_u32 s36, s36, s25
    buffer_load_dwordx4 v14, s[64:67], s36 offen lds
    buffer_load_dwordx4 v15, s[64:67], s36 offen offset:1024 lds
    s_lshl_b32 s25, s20, 11
    s_add_u32 m0, s25, 81920
    s_add_u32 s35, s35, 1
    s_cmp_eq_u32 s35, 14
    s_cselect_b32 s25, -13, 1
    s_mul_i32 s25, s25, 28672
    s_add_u32 s36, s36, s25
    buffer_load_dwordx4 v14, s[64:67], s36 offen lds
    buffer_load_dwordx4 v15, s[64:67], s36 offen offset:1024 lds
    s_lshl_b32 s25, s20, 11
    s_add_u32 m0, s25, 98304
    s_add_u32 s35, s35, 1
    s_cmp_eq_u32 s35, 14
    s_cselect_b32 s25, -13, 1
    s_mul_i32 s25, s25, 28672
    s_add_u32 s36, s36, s25
    buffer_load_dwordx4 v14, s[64:67], s36 offen lds
    buffer_load_dwordx4 v15, s[64:67], s36 offen offset:1024 lds
    s_lshr_b32 s39, s20, 1
    s_lshl_b32 s33, s21, 1
    s_and_b32 s24, s20, 1
    s_add_u32 s33, s33, s24
    s_lshl_b32 s23, s33, 2
    s_add_u32 s23, s23, s39
    s_mul_i32 s37, s23, 28672
    s_lshl_b32 s23, s31, 11
    s_add_u32 s37, s37, s23
    s_add_u32 s37, s37, 4243456
    s_mul_i32 s24, s21, 7
    s_add_u32 s24, s24, s22
    s_lshl_b32 s24, s24, 7
    s_add_u32 s24, s24, 11616256
    v_bfe_u32 v7, v0, 2, 2
    v_lshl_add_u32 v6, v9, 4, v7
    v_lshlrev_b32 v6, 7, v6
    v_bfe_u32 v5, v0, 7, 2
    v_lshl_add_u32 v6, v5, 12, v6
    v_lshrrev_b32 v7, 1, v7
    v_bfe_u32 v5, v0, 8, 1
    v_xor_b32 v7, v7, v5
    v_lshl_add_u32 v6, v7, 6, v6
    v_and_b32 v7, 1, v0
    v_lshl_add_u32 v6, v7, 5, v6
    v_bfe_u32 v7, v0, 4, 1
    v_bfe_u32 v5, v0, 7, 1
    v_xor_b32 v7, v7, v5
    v_lshl_add_u32 v6, v7, 4, v6
    v_bfe_u32 v7, v0, 1, 1
    v_lshl_add_u32 v196, v7, 3, v6
    v_xor_b32 v197, 64, v196
    v_add_u32 v198, 0x10000, v196
    v_add_u32 v199, 0x10000, v197
    v_add_u32 v200, 0x20000, v196
    v_add_u32 v201, 0x20000, v197
    s_mul_i32 s23, s33, 28
    s_lshl_b32 s25, s22, 2
    s_add_u32 s23, s23, s25
    s_add_u32 s23, s23, s39
    s_lshl_b32 s23, s23, 10
    s_add_u32 s23, s23, 2162688
    buffer_load_dwordx4 v[192:195], v1, s[12:15], s23 offen sc1
    v_lshrrev_b32 v5, 6, v0
    s_movk_i32 s25, 6144
    v_add_u32 v6, 16384, v1
    v_mad_u32_u24 v10, v5, s25, v6
    v_xor_b32 v11, 2, v5
    v_mad_u32_u24 v11, v11, s25, v6
    v_xor_b32 v12, 4, v5
    v_mad_u32_u24 v12, v12, s25, v6
    v_xor_b32 v13, 6, v5
    v_mad_u32_u24 v13, v13, s25, v6
    v_and_b32 v5, 31, v0
    v_mul_u32_u24 v4, 896, v5
    v_lshl_add_u32 v4, v9, 5, v4
    s_mul_i32 s23, s33, 28672
    s_add_u32 s23, s23, s30
    s_lshr_b32 s25, s39, 1
    s_lshl_b32 s25, s25, 6
    s_add_u32 s23, s23, s25
    s_and_b32 s25, s39, 1
    s_lshl_b32 s25, s25, 4
    s_add_u32 s23, s23, s25
    v_lshrrev_b32 v5, 6, v0
    v_lshl_add_u32 v202, v5, 11, v1
    v_add_u32 v203, 114688, v202
    s_cmp_lg_u32 s20, 4
    s_cbranch_scc1 Lkf_p2dr
    s_mov_b32 s72, 0x200000
    v_mov_b32 v2, 0
Lkf_p2:
    buffer_load_dword v3, v2, s[12:15], s24 offen sc1
    s_waitcnt vmcnt(0)
    v_cmp_gt_u32 vcc, 28, v3
    s_cbranch_vccz Lkf_p2ok
    s_sleep 1
    s_sub_u32 s72, s72, 1
    s_cbranch_scc0 Lkf_p2
Lkf_p2dr:
    s_waitcnt vmcnt(0)
Lkf_p2ok:
    s_barrier
    buffer_load_dwordx4 v[16:19], v1, s[12:15], s37 offen offset:0 sc1
    buffer_load_dwordx4 v[20:23], v1, s[12:15], s37 offen offset:1024 sc1
    s_barrier
    s_add_u32 s31, s31, 1
    s_cmp_eq_u32 s31, 14
    s_cselect_b32 s25, -13, 1
    s_lshl_b32 s25, s25, 11
    s_add_u32 s37, s37, s25
    buffer_load_dwordx4 v[24:27], v1, s[12:15], s37 offen offset:0 sc1
    buffer_load_dwordx4 v[28:31], v1, s[12:15], s37 offen offset:1024 sc1
    s_add_u32 s31, s31, 1
    s_cmp_eq_u32 s31, 14
    s_cselect_b32 s25, -13, 1
    s_lshl_b32 s25, s25, 11
    s_add_u32 s37, s37, s25
    buffer_load_dwordx4 v[32:35], v1, s[12:15], s37 offen offset:0 sc1
    buffer_load_dwordx4 v[36:39], v1, s[12:15], s37 offen offset:1024 sc1
    s_add_u32 s31, s31, 1
    s_cmp_eq_u32 s31, 14
    s_cselect_b32 s25, -13, 1
    s_lshl_b32 s25, s25, 11
    s_add_u32 s37, s37, s25
    buffer_load_dwordx4 v[72:75], v1, s[12:15], s37 offen offset:0 sc1
    buffer_load_dwordx4 v[76:79], v1, s[12:15], s37 offen offset:1024 sc1
    ds_read_b64_tr_b16 v[160:161], v198 offset:49152
    ds_read_b64_tr_b16 v[162:163], v198 offset:49664
    ds_read_b64_tr_b16 v[164:165], v199 offset:49152
    ds_read_b64_tr_b16 v[166:167], v199 offset:49664
    ds_read_b64_tr_b16 v[168:169], v198 offset:50176
    ds_read_b64_tr_b16 v[170:171], v198 offset:50688
    ds_read_b64_tr_b16 v[172:173], v199 offset:50176
    ds_read_b64_tr_b16 v[174:175], v199 offset:50688
    ds_read_b64_tr_b16 v[176:177], v200 offset:0
    ds_read_b64_tr_b16 v[178:179], v200 offset:512
    ds_read_b64_tr_b16 v[180:181], v201 offset:0
    ds_read_b64_tr_b16 v[182:183], v201 offset:512
    s_waitcnt vmcnt(6)
    s_waitcnt lgkmcnt(10)
    v_mfma_f32_32x32x16_bf16 v[128:143], v[160:163], v[16:19], 0
    ds_read_b64_tr_b16 v[160:161], v200 offset:1024
    ds_read_b64_tr_b16 v[162:163], v200 offset:1536
    s_waitcnt lgkmcnt(10)
    v_mfma_f32_32x32x16_bf16 v[144:159], v[164:167], v[16:19], 0
    ds_read_b64_tr_b16 v[164:165], v201 offset:1024
    ds_read_b64_tr_b16 v[166:167], v201 offset:1536
    s_waitcnt lgkmcnt(10)
    v_mfma_f32_32x32x16_bf16 v[128:143], v[168:171], v[20:23], v[128:143]
    ds_read_b64_tr_b16 v[168:169], v200 offset:16384
    ds_read_b64_tr_b16 v[170:171], v200 offset:16896
    s_waitcnt lgkmcnt(10)
    v_mfma_f32_32x32x16_bf16 v[144:159], v[172:175], v[20:23], v[144:159]
    s_add_u32 s31, s31, 1
    s_cmp_eq_u32 s31, 14
    s_cselect_b32 s25, -13, 1
    s_lshl_b32 s25, s25, 11
    s_add_u32 s37, s37, s25
    buffer_load_dwordx4 v[80:83], v1, s[12:15], s37 offen offset:0 sc1
    buffer_load_dwordx4 v[84:87], v1, s[12:15], s37 offen offset:1024 sc1
    ds_read_b64_tr_b16 v[172:173], v201 offset:16384
    ds_read_b64_tr_b16 v[174:175], v201 offset:16896
    s_waitcnt vmcnt(6)
    s_waitcnt lgkmcnt(10)
    v_mfma_f32_32x32x16_bf16 v[128:143], v[176:179], v[24:27], v[128:143]
    ds_read_b64_tr_b16 v[176:177], v200 offset:17408
    ds_read_b64_tr_b16 v[178:179], v200 offset:17920
    s_waitcnt lgkmcnt(10)
    v_mfma_f32_32x32x16_bf16 v[144:159], v[180:183], v[24:27], v[144:159]
    ds_read_b64_tr_b16 v[180:181], v201 offset:17408
    ds_read_b64_tr_b16 v[182:183], v201 offset:17920
    s_waitcnt lgkmcnt(10)
    v_mfma_f32_32x32x16_bf16 v[128:143], v[160:163], v[28:31], v[128:143]
    ds_read_b64_tr_b16 v[160:161], v196 offset:0
    ds_read_b64_tr_b16 v[162:163], v196 offset:512
    s_waitcnt lgkmcnt(10)
    v_mfma_f32_32x32x16_bf16 v[144:159], v[164:167], v[28:31], v[144:159]
    s_add_u32 s31, s31, 1
    s_cmp_eq_u32 s31, 14
    s_cselect_b32 s25, -13, 1
    s_lshl_b32 s25, s25, 11
    s_add_u32 s37, s37, s25
    buffer_load_dwordx4 v[88:91], v1, s[12:15], s37 offen offset:0 sc1
    buffer_load_dwordx4 v[92:95], v1, s[12:15], s37 offen offset:1024 sc1
    ds_read_b64_tr_b16 v[164:165], v197 offset:0
    ds_read_b64_tr_b16 v[166:167], v197 offset:512
    s_waitcnt vmcnt(6)
    s_waitcnt lgkmcnt(10)
    v_mfma_f32_32x32x16_bf16 v[128:143], v[168:171], v[32:35], v[128:143]
    ds_read_b64_tr_b16 v[168:169], v196 offset:1024
    ds_read_b64_tr_b16 v[170:171], v196 offset:1536
    s_waitcnt lgkmcnt(10)
    v_mfma_f32_32x32x16_bf16 v[144:159], v[172:175], v[32:35], v[144:159]
    ds_read_b64_tr_b16 v[172:173], v197 offset:1024
    ds_read_b64_tr_b16 v[174:175], v197 offset:1536
    s_waitcnt lgkmcnt(10)
    v_mfma_f32_32x32x16_bf16 v[128:143], v[176:179], v[36:39], v[128:143]
    ds_read_b64_tr_b16 v[176:177], v196 offset:16384
    ds_read_b64_tr_b16 v[178:179], v196 offset:16896
    s_waitcnt lgkmcnt(10)
    v_mfma_f32_32x32x16_bf16 v[144:159], v[180:183], v[36:39], v[144:159]
    s_add_u32 s31, s31, 1
    s_cmp_eq_u32 s31, 14
    s_cselect_b32 s25, -13, 1
    s_lshl_b32 s25, s25, 11
    s_add_u32 s37, s37, s25
    buffer_load_dwordx4 v[96:99], v1, s[12:15], s37 offen offset:0 sc1
    buffer_load_dwordx4 v[100:103], v1, s[12:15], s37 offen offset:1024 sc1
    ds_read_b64_tr_b16 v[180:181], v197 offset:16384
    ds_read_b64_tr_b16 v[182:183], v197 offset:16896
    s_waitcnt vmcnt(6)
    s_waitcnt lgkmcnt(10)
    v_mfma_f32_32x32x16_bf16 v[128:143], v[160:163], v[72:75], v[128:143]
    ds_read_b64_tr_b16 v[160:161], v196 offset:17408
    ds_read_b64_tr_b16 v[162:163], v196 offset:17920
    s_waitcnt lgkmcnt(10)
    v_mfma_f32_32x32x16_bf16 v[144:159], v[164:167], v[72:75], v[144:159]
    ds_read_b64_tr_b16 v[164:165], v197 offset:17408
    ds_read_b64_tr_b16 v[166:167], v197 offset:17920
    s_waitcnt lgkmcnt(10)
    v_mfma_f32_32x32x16_bf16 v[128:143], v[168:171], v[76:79], v[128:143]
    ds_read_b64_tr_b16 v[168:169], v196 offset:32768
    ds_read_b64_tr_b16 v[170:171], v196 offset:33280
    s_waitcnt lgkmcnt(10)
    v_mfma_f32_32x32x16_bf16 v[144:159], v[172:175], v[76:79], v[144:159]
    s_add_u32 s31, s31, 1
    s_cmp_eq_u32 s31, 14
    s_cselect_b32 s25, -13, 1
    s_lshl_b32 s25, s25, 11
    s_add_u32 s37, s37, s25
    buffer_load_dwordx4 v[104:107], v1, s[12:15], s37 offen offset:0 sc1
    buffer_load_dwordx4 v[108:111], v1, s[12:15], s37 offen offset:1024 sc1
    ds_read_b64_tr_b16 v[172:173], v197 offset:32768
    ds_read_b64_tr_b16 v[174:175], v197 offset:33280
    s_waitcnt vmcnt(6)
    s_waitcnt lgkmcnt(10)
    v_mfma_f32_32x32x16_bf16 v[128:143], v[176:179], v[80:83], v[128:143]
    ds_read_b64_tr_b16 v[176:177], v196 offset:33792
    ds_read_b64_tr_b16 v[178:179], v196 offset:34304
    s_waitcnt lgkmcnt(10)
    v_mfma_f32_32x32x16_bf16 v[144:159], v[180:183], v[80:83], v[144:159]
    ds_read_b64_tr_b16 v[180:181], v197 offset:33792
    ds_read_b64_tr_b16 v[182:183], v197 offset:34304
    s_waitcnt lgkmcnt(10)
    v_mfma_f32_32x32x16_bf16 v[128:143], v[160:163], v[84:87], v[128:143]
    s_barrier
    ds_read_b64_tr_b16 v[160:161], v196 offset:49152
    ds_read_b64_tr_b16 v[162:163], v196 offset:49664
    s_waitcnt lgkmcnt(10)
    v_mfma_f32_32x32x16_bf16 v[144:159], v[164:167], v[84:87], v[144:159]
    s_add_u32 s31, s31, 1
    s_cmp_eq_u32 s31, 14
    s_cselect_b32 s25, -13, 1
    s_lshl_b32 s25, s25, 11
    s_add_u32 s37, s37, s25
    buffer_load_dwordx4 v[112:115], v1, s[12:15], s37 offen offset:0 sc1
    buffer_load_dwordx4 v[116:119], v1, s[12:15], s37 offen offset:1024 sc1
    ds_write_b128 v203, v[40:43] offset:0
    ds_read_b64_tr_b16 v[164:165], v197 offset:49152
    ds_read_b64_tr_b16 v[166:167], v197 offset:49664
    s_waitcnt vmcnt(6)
    s_waitcnt lgkmcnt(10)
    v_mfma_f32_32x32x16_bf16 v[128:143], v[168:171], v[88:91], v[128:143]
    ds_write_b128 v203, v[44:47] offset:1024
    ds_read_b64_tr_b16 v[168:169], v196 offset:50176
    ds_read_b64_tr_b16 v[170:171], v196 offset:50688
    s_waitcnt lgkmcnt(10)
    v_mfma_f32_32x32x16_bf16 v[144:159], v[172:175], v[88:91], v[144:159]
    ds_write_b128 v203, v[48:51] offset:16384
    ds_read_b64_tr_b16 v[172:173], v197 offset:50176
    ds_read_b64_tr_b16 v[174:175], v197 offset:50688
    s_waitcnt lgkmcnt(10)
    v_mfma_f32_32x32x16_bf16 v[128:143], v[176:179], v[92:95], v[128:143]
    ds_write_b128 v203, v[52:55] offset:17408
    ds_read_b64_tr_b16 v[176:177], v198 offset:0
    ds_read_b64_tr_b16 v[178:179], v198 offset:512
    s_waitcnt lgkmcnt(10)
    v_mfma_f32_32x32x16_bf16 v[144:159], v[180:183], v[92:95], v[144:159]
    s_add_u32 s31, s31, 1
    s_cmp_eq_u32 s31, 14
    s_cselect_b32 s25, -13, 1
    s_lshl_b32 s25, s25, 11
    s_add_u32 s37, s37, s25
    buffer_load_dwordx4 v[120:123], v1, s[12:15], s37 offen offset:0 sc1
    buffer_load_dwordx4 v[124:127], v1, s[12:15], s37 offen offset:1024 sc1
    ds_write_b128 v203, v[56:59] offset:32768
    ds_read_b64_tr_b16 v[180:181], v199 offset:0
    ds_read_b64_tr_b16 v[182:183], v199 offset:512
    s_waitcnt vmcnt(6)
    s_waitcnt lgkmcnt(10)
    v_mfma_f32_32x32x16_bf16 v[128:143], v[160:163], v[96:99], v[128:143]
    ds_write_b128 v203, v[60:63] offset:33792
    ds_read_b64_tr_b16 v[160:161], v198 offset:1024
    ds_read_b64_tr_b16 v[162:163], v198 offset:1536
    s_waitcnt lgkmcnt(10)
    v_mfma_f32_32x32x16_bf16 v[144:159], v[164:167], v[96:99], v[144:159]
    ds_write_b128 v202, v[64:67] offset:0
    ds_read_b64_tr_b16 v[164:165], v199 offset:1024
    ds_read_b64_tr_b16 v[166:167], v199 offset:1536
    s_waitcnt lgkmcnt(10)
    v_mfma_f32_32x32x16_bf16 v[128:143], v[168:171], v[100:103], v[128:143]
    ds_write_b128 v202, v[68:71] offset:1024
    ds_read_b64_tr_b16 v[168:169], v198 offset:16384
    ds_read_b64_tr_b16 v[170:171], v198 offset:16896
    s_waitcnt lgkmcnt(10)
    v_mfma_f32_32x32x16_bf16 v[144:159], v[172:175], v[100:103], v[144:159]
    s_add_u32 s31, s31, 1
    s_cmp_eq_u32 s31, 14
    s_cselect_b32 s25, -13, 1
    s_lshl_b32 s25, s25, 11
    s_add_u32 s37, s37, s25
    buffer_load_dwordx4 v[208:211], v1, s[12:15], s37 offen offset:0 sc1
    buffer_load_dwordx4 v[212:215], v1, s[12:15], s37 offen offset:1024 sc1
    ds_read_b64_tr_b16 v[172:173], v199 offset:16384
    ds_read_b64_tr_b16 v[174:175], v199 offset:16896
    s_waitcnt vmcnt(6)
    s_waitcnt lgkmcnt(10)
    v_mfma_f32_32x32x16_bf16 v[128:143], v[176:179], v[104:107], v[128:143]
    ds_read_b64_tr_b16 v[176:177], v198 offset:17408
    ds_read_b64_tr_b16 v[178:179], v198 offset:17920
    s_waitcnt lgkmcnt(10)
    v_mfma_f32_32x32x16_bf16 v[144:159], v[180:183], v[104:107], v[144:159]
    ds_read_b64_tr_b16 v[180:181], v199 offset:17408
    ds_read_b64_tr_b16 v[182:183], v199 offset:17920
    s_waitcnt lgkmcnt(10)
    v_mfma_f32_32x32x16_bf16 v[128:143], v[160:163], v[108:111], v[128:143]
    ds_read_b64_tr_b16 v[160:161], v198 offset:32768
    ds_read_b64_tr_b16 v[162:163], v198 offset:33280
    s_waitcnt lgkmcnt(10)
    v_mfma_f32_32x32x16_bf16 v[144:159], v[164:167], v[108:111], v[144:159]
    s_add_u32 s31, s31, 1
    s_cmp_eq_u32 s31, 14
    s_cselect_b32 s25, -13, 1
    s_lshl_b32 s25, s25, 11
    s_add_u32 s37, s37, s25
    buffer_load_dwordx4 v[216:219], v1, s[12:15], s37 offen offset:0 sc1
    buffer_load_dwordx4 v[220:223], v1, s[12:15], s37 offen offset:1024 sc1
    ds_read_b64_tr_b16 v[164:165], v199 offset:32768
    ds_read_b64_tr_b16 v[166:167], v199 offset:33280
    s_waitcnt vmcnt(6)
    s_waitcnt lgkmcnt(10)
    v_mfma_f32_32x32x16_bf16 v[128:143], v[168:171], v[112:115], v[128:143]
    ds_read_b64_tr_b16 v[168:169], v198 offset:33792
    ds_read_b64_tr_b16 v[170:171], v198 offset:34304
    s_waitcnt lgkmcnt(10)
    v_mfma_f32_32x32x16_bf16 v[144:159], v[172:175], v[112:115], v[144:159]
    ds_read_b64_tr_b16 v[172:173], v199 offset:33792
    ds_read_b64_tr_b16 v[174:175], v199 offset:34304
    s_waitcnt lgkmcnt(10)
    v_mfma_f32_32x32x16_bf16 v[128:143], v[176:179], v[116:119], v[128:143]
    s_barrier
    ds_read_b64_tr_b16 v[176:177], v198 offset:49152
    ds_read_b64_tr_b16 v[178:179], v198 offset:49664
    s_waitcnt lgkmcnt(10)
    v_mfma_f32_32x32x16_bf16 v[144:159], v[180:183], v[116:119], v[144:159]
    s_add_u32 s31, s31, 1
    s_cmp_eq_u32 s31, 14
    s_cselect_b32 s25, -13, 1
    s_lshl_b32 s25, s25, 11
    s_add_u32 s37, s37, s25
    buffer_load_dwordx4 v[224:227], v1, s[12:15], s37 offen offset:0 sc1
    buffer_load_dwordx4 v[228:231], v1, s[12:15], s37 offen offset:1024 sc1
    ds_read_b64_tr_b16 v[180:181], v199 offset:49152
    ds_read_b64_tr_b16 v[182:183], v199 offset:49664
    s_waitcnt vmcnt(6)
    s_waitcnt lgkmcnt(10)
    v_mfma_f32_32x32x16_bf16 v[128:143], v[160:163], v[120:123], v[128:143]
    ds_read_b64_tr_b16 v[160:161], v198 offset:50176
    ds_read_b64_tr_b16 v[162:163], v198 offset:50688
    s_waitcnt lgkmcnt(10)
    v_mfma_f32_32x32x16_bf16 v[144:159], v[164:167], v[120:123], v[144:159]
    ds_read_b64_tr_b16 v[164:165], v199 offset:50176
    ds_read_b64_tr_b16 v[166:167], v199 offset:50688
    s_waitcnt lgkmcnt(10)
    v_mfma_f32_32x32x16_bf16 v[128:143], v[168:171], v[124:127], v[128:143]
    ds_read_b64_tr_b16 v[168:169], v201 offset:0
    ds_read_b64_tr_b16 v[170:171], v201 offset:512
    s_waitcnt lgkmcnt(10)
    v_mfma_f32_32x32x16_bf16 v[144:159], v[172:175], v[124:127], v[144:159]
    s_add_u32 s31, s31, 1
    s_cmp_eq_u32 s31, 14
    s_cselect_b32 s25, -13, 1
    s_lshl_b32 s25, s25, 11
    s_add_u32 s37, s37, s25
    buffer_load_dwordx4 v[232:235], v1, s[12:15], s37 offen offset:0 sc1
    buffer_load_dwordx4 v[236:239], v1, s[12:15], s37 offen offset:1024 sc1
    ds_read_b64_tr_b16 v[172:173], v201 offset:1024
    ds_read_b64_tr_b16 v[174:175], v201 offset:1536
    s_waitcnt vmcnt(6)
    s_waitcnt lgkmcnt(10)
    v_mfma_f32_32x32x16_bf16 v[128:143], v[176:179], v[208:211], v[128:143]
    ds_read_b64_tr_b16 v[176:177], v201 offset:16384
    ds_read_b64_tr_b16 v[178:179], v201 offset:16896
    s_waitcnt lgkmcnt(10)
    v_mfma_f32_32x32x16_bf16 v[144:159], v[180:183], v[208:211], v[144:159]
    ds_read_b64_tr_b16 v[180:181], v201 offset:17408
    ds_read_b64_tr_b16 v[182:183], v201 offset:17920
    s_waitcnt lgkmcnt(10)
    v_mfma_f32_32x32x16_bf16 v[128:143], v[160:163], v[212:215], v[128:143]
    ds_read_b64_tr_b16 v[160:161], v197 offset:0
    ds_read_b64_tr_b16 v[162:163], v197 offset:512
    s_waitcnt lgkmcnt(10)
    v_mfma_f32_32x32x16_bf16 v[144:159], v[164:167], v[212:215], v[144:159]
    ds_read_b64_tr_b16 v[164:165], v197 offset:1024
    ds_read_b64_tr_b16 v[166:167], v197 offset:1536
    s_waitcnt vmcnt(4)
    s_waitcnt lgkmcnt(10)
    v_mfma_f32_32x32x16_bf16 v[144:159], v[168:171], v[216:219], v[144:159]
    ds_read_b64_tr_b16 v[168:169], v200 offset:0
    ds_read_b64_tr_b16 v[170:171], v200 offset:512
    s_waitcnt lgkmcnt(10)
    v_mfma_f32_32x32x16_bf16 v[144:159], v[172:175], v[220:223], v[144:159]
    ds_read_b64_tr_b16 v[172:173], v200 offset:1024
    ds_read_b64_tr_b16 v[174:175], v200 offset:1536
    s_waitcnt vmcnt(2)
    s_waitcnt lgkmcnt(10)
    v_mfma_f32_32x32x16_bf16 v[144:159], v[176:179], v[224:227], v[144:159]
    ds_read_b64_tr_b16 v[176:177], v200 offset:16384
    ds_read_b64_tr_b16 v[178:179], v200 offset:16896
    s_waitcnt lgkmcnt(10)
    v_mfma_f32_32x32x16_bf16 v[144:159], v[180:183], v[228:231], v[144:159]
    ds_read_b64_tr_b16 v[180:181], v200 offset:17408
    ds_read_b64_tr_b16 v[182:183], v200 offset:17920
    s_waitcnt vmcnt(0)
    s_waitcnt lgkmcnt(10)
    v_mfma_f32_32x32x16_bf16 v[144:159], v[160:163], v[232:235], v[144:159]
    ds_read_b64_tr_b16 v[160:161], v196 offset:0
    ds_read_b64_tr_b16 v[162:163], v196 offset:512
    s_waitcnt lgkmcnt(10)
    v_mfma_f32_32x32x16_bf16 v[144:159], v[164:167], v[236:239], v[144:159]
    ds_read_b64_tr_b16 v[164:165], v196 offset:1024
    ds_read_b64_tr_b16 v[166:167], v196 offset:1536
    s_waitcnt lgkmcnt(10)
    v_mfma_f32_32x32x16_bf16 v[128:143], v[168:171], v[216:219], v[128:143]
    s_waitcnt lgkmcnt(8)
    v_mfma_f32_32x32x16_bf16 v[128:143], v[172:175], v[220:223], v[128:143]
    v_lshlrev_b32 v16, 16, v192
    v_and_b32 v17, 0xffff0000, v192
    v_lshlrev_b32 v18, 16, v193
    v_and_b32 v19, 0xffff0000, v193
    v_lshlrev_b32 v20, 16, v194
    v_and_b32 v21, 0xffff0000, v194
    v_lshlrev_b32 v22, 16, v195
    v_and_b32 v23, 0xffff0000, v195
    s_waitcnt lgkmcnt(6)
    v_mfma_f32_32x32x16_bf16 v[128:143], v[176:179], v[224:227], v[128:143]
    ds_write_b128 v12, v[144:147] offset:2048
    ds_write_b128 v12, v[148:151] offset:3072
    s_waitcnt lgkmcnt(4)
    v_mfma_f32_32x32x16_bf16 v[128:143], v[180:183], v[228:231], v[128:143]
    ds_write_b128 v13, v[152:155] offset:4096
    ds_write_b128 v13, v[156:159] offset:5120
    s_waitcnt lgkmcnt(2)
    v_mfma_f32_32x32x16_bf16 v[128:143], v[160:163], v[232:235], v[128:143]
    s_waitcnt lgkmcnt(0)
    v_mfma_f32_32x32x16_bf16 v[128:143], v[164:167], v[236:239], v[128:143]
    s_nop 11
    ds_write_b128 v11, v[136:139] offset:0
    ds_write_b128 v11, v[140:143] offset:1024
    v_pk_add_f32 v[128:129], v[128:129], v[16:17]
    v_pk_add_f32 v[130:131], v[130:131], v[18:19]
    v_pk_add_f32 v[132:133], v[132:133], v[20:21]
    v_pk_add_f32 v[134:135], v[134:135], v[22:23]
    s_waitcnt lgkmcnt(0)
    s_barrier
    ds_read_b128 v[24:27], v10 offset:0
    ds_read_b128 v[28:31], v10 offset:1024
    ds_read_b128 v[32:35], v10 offset:2048
    ds_read_b128 v[36:39], v10 offset:3072
    ds_read_b128 v[40:43], v10 offset:4096
    ds_read_b128 v[44:47], v10 offset:5120
    s_waitcnt lgkmcnt(4)
    v_pk_add_f32 v[128:129], v[128:129], v[24:25]
    v_pk_add_f32 v[130:131], v[130:131], v[26:27]
    v_pk_add_f32 v[132:133], v[132:133], v[28:29]
    v_pk_add_f32 v[134:135], v[134:135], v[30:31]
    s_waitcnt lgkmcnt(2)
    v_pk_add_f32 v[128:129], v[128:129], v[32:33]
    v_pk_add_f32 v[130:131], v[130:131], v[34:35]
    v_pk_add_f32 v[132:133], v[132:133], v[36:37]
    v_pk_add_f32 v[134:135], v[134:135], v[38:39]
    s_waitcnt lgkmcnt(0)
    v_pk_add_f32 v[128:129], v[128:129], v[40:41]
    v_pk_add_f32 v[130:131], v[130:131], v[42:43]
    v_pk_add_f32 v[132:133], v[132:133], v[44:45]
    v_pk_add_f32 v[134:135], v[134:135], v[46:47]
    v_cvt_pk_bf16_f32 v16, v128, v129
    v_cvt_pk_bf16_f32 v17, v130, v131
    v_cvt_pk_bf16_f32 v18, v132, v133
    v_cvt_pk_bf16_f32 v19, v134, v135
    buffer_store_dwordx4 v[16:19], v4, s[68:71], s23 offen
    s_endpgm
Lkf_cs:
    s_mov_b32 s66, 1605632
    s_mov_b32 s67, 0x20000
    s_sub_u32 s22, s2, 224
    s_mul_i32 s34, s22, 50176
    v_min_u32 v2, 391, v0
    v_lshlrev_b32 v2, 7, v2
    s_cmp_lt_u32 s2, 252
    s_cbranch_scc1 Lkf_cs1
    s_waitcnt lgkmcnt(0)
    buffer_load_dword v100, v2, s[64:67], s34 offen
    s_endpgm
Lkf_cs1:
    v_lshrrev_b32 v5, 6, v0
    v_bfe_u32 v6, v0, 3, 3
    v_readfirstlane_b32 s20, v5
    v_and_b32 v7, 7, v0
    v_mul_u32_u24 v1, 3584, v6
    v_lshl_add_u32 v1, v7, 4, v1
    s_sub_u32 s22, s2, 224
    s_and_b32 s23, s20, 3
    s_mul_i32 s23, s23, 401408
    s_lshl_b32 s24, s22, 7
    s_add_u32 s23, s23, s24
    s_mov_b32 s26, 0x3f80
    s_mov_b32 s27, 0x3f800000
    s_mov_b32 s10, 1605632
    s_mov_b32 s11, 0x20000
    s_mov_b32 s14, 11730944
    s_mov_b32 s15, 0x20000
    s_waitcnt lgkmcnt(0)
    s_cmp_ge_u32 s20, 4
    s_cselect_b32 s8, s60, s56
    s_cselect_b32 s9, s61, s57
    buffer_load_dwordx4 v[16:19], v1, s[8:11], s23 offen
    s_add_u32 s23, s23, 28672
    buffer_load_dwordx4 v[20:23], v1, s[8:11], s23 offen
    s_add_u32 s23, s23, 28672
    buffer_load_dwordx4 v[24:27], v1, s[8:11], s23 offen
    s_add_u32 s23, s23, 28672
    buffer_load_dwordx4 v[28:31], v1, s[8:11], s23 offen
    s_add_u32 s23, s23, 28672
    buffer_load_dwordx4 v[32:35], v1, s[8:11], s23 offen
    s_add_u32 s23, s23, 28672
    buffer_load_dwordx4 v[36:39], v1, s[8:11], s23 offen
    s_add_u32 s23, s23, 28672
    buffer_load_dwordx4 v[40:43], v1, s[8:11], s23 offen
    s_add_u32 s23, s23, 28672
    buffer_load_dwordx4 v[44:47], v1, s[8:11], s23 offen
    s_add_u32 s23, s23, 28672
    buffer_load_dwordx4 v[48:51], v1, s[8:11], s23 offen
    s_add_u32 s23, s23, 28672
    buffer_load_dwordx4 v[52:55], v1, s[8:11], s23 offen
    s_add_u32 s23, s23, 28672
    buffer_load_dwordx4 v[56:59], v1, s[8:11], s23 offen
    s_add_u32 s23, s23, 28672
    buffer_load_dwordx4 v[60:63], v1, s[8:11], s23 offen
    s_add_u32 s23, s23, 28672
    buffer_load_dwordx4 v[64:67], v1, s[8:11], s23 offen
    s_add_u32 s23, s23, 28672
    buffer_load_dwordx4 v[68:71], v1, s[8:11], s23 offen
    s_add_u32 s23, s23, 28672
    v_mov_b32 v8, 0
    v_mov_b32 v9, 0
    v_mov_b32 v10, 0
    v_mov_b32 v11, 0
    v_mov_b32 v12, 0
    v_mov_b32 v13, 0
    v_mov_b32 v14, 0
    v_mov_b32 v15, 0
    s_waitcnt vmcnt(13)
    v_dot2c_f32_bf16 v8, s26, v16
    v_dot2c_f32_bf16 v9, s27, v16
    v_dot2c_f32_bf16 v10, s26, v17
    v_dot2c_f32_bf16 v11, s27, v17
    v_dot2c_f32_bf16 v12, s26, v18
    v_dot2c_f32_bf16 v13, s27, v18
    v_dot2c_f32_bf16 v14, s26, v19
    v_dot2c_f32_bf16 v15, s27, v19
    s_waitcnt vmcnt(12)
    v_dot2c_f32_bf16 v8, s26, v20
    v_dot2c_f32_bf16 v9, s27, v20
    v_dot2c_f32_bf16 v10, s26, v21
    v_dot2c_f32_bf16 v11, s27, v21
    v_dot2c_f32_bf16 v12, s26, v22
    v_dot2c_f32_bf16 v13, s27, v22
    v_dot2c_f32_bf16 v14, s26, v23
    v_dot2c_f32_bf16 v15, s27, v23
    s_waitcnt vmcnt(11)
    v_dot2c_f32_bf16 v8, s26, v24
    v_dot2c_f32_bf16 v9, s27, v24
    v_dot2c_f32_bf16 v10, s26, v25
    v_dot2c_f32_bf16 v11, s27, v25
    v_dot2c_f32_bf16 v12, s26, v26
    v_dot2c_f32_bf16 v13, s27, v26
    v_dot2c_f32_bf16 v14, s26, v27
    v_dot2c_f32_bf16 v15, s27, v27
    s_waitcnt vmcnt(10)
    v_dot2c_f32_bf16 v8, s26, v28
    v_dot2c_f32_bf16 v9, s27, v28
    v_dot2c_f32_bf16 v10, s26, v29
    v_dot2c_f32_bf16 v11, s27, v29
    v_dot2c_f32_bf16 v12, s26, v30
    v_dot2c_f32_bf16 v13, s27, v30
    v_dot2c_f32_bf16 v14, s26, v31
    v_dot2c_f32_bf16 v15, s27, v31
    s_waitcnt vmcnt(9)
    v_dot2c_f32_bf16 v8, s26, v32
    v_dot2c_f32_bf16 v9, s27, v32
    v_dot2c_f32_bf16 v10, s26, v33
    v_dot2c_f32_bf16 v11, s27, v33
    v_dot2c_f32_bf16 v12, s26, v34
    v_dot2c_f32_bf16 v13, s27, v34
    v_dot2c_f32_bf16 v14, s26, v35
    v_dot2c_f32_bf16 v15, s27, v35
    s_waitcnt vmcnt(8)
    v_dot2c_f32_bf16 v8, s26, v36
    v_dot2c_f32_bf16 v9, s27, v36
    v_dot2c_f32_bf16 v10, s26, v37
    v_dot2c_f32_bf16 v11, s27, v37
    v_dot2c_f32_bf16 v12, s26, v38
    v_dot2c_f32_bf16 v13, s27, v38
    v_dot2c_f32_bf16 v14, s26, v39
    v_dot2c_f32_bf16 v15, s27, v39
    s_waitcnt vmcnt(7)
    v_dot2c_f32_bf16 v8, s26, v40
    v_dot2c_f32_bf16 v9, s27, v40
    v_dot2c_f32_bf16 v10, s26, v41
    v_dot2c_f32_bf16 v11, s27, v41
    v_dot2c_f32_bf16 v12, s26, v42
    v_dot2c_f32_bf16 v13, s27, v42
    v_dot2c_f32_bf16 v14, s26, v43
    v_dot2c_f32_bf16 v15, s27, v43
    s_waitcnt vmcnt(6)
    v_dot2c_f32_bf16 v8, s26, v44
    v_dot2c_f32_bf16 v9, s27, v44
    v_dot2c_f32_bf16 v10, s26, v45
    v_dot2c_f32_bf16 v11, s27, v45
    v_dot2c_f32_bf16 v12, s26, v46
    v_dot2c_f32_bf16 v13, s27, v46
    v_dot2c_f32_bf16 v14, s26, v47
    v_dot2c_f32_bf16 v15, s27, v47
    s_waitcnt vmcnt(5)
    v_dot2c_f32_bf16 v8, s26, v48
    v_dot2c_f32_bf16 v9, s27, v48
    v_dot2c_f32_bf16 v10, s26, v49
    v_dot2c_f32_bf16 v11, s27, v49
    v_dot2c_f32_bf16 v12, s26, v50
    v_dot2c_f32_bf16 v13, s27, v50
    v_dot2c_f32_bf16 v14, s26, v51
    v_dot2c_f32_bf16 v15, s27, v51
    s_waitcnt vmcnt(4)
    v_dot2c_f32_bf16 v8, s26, v52
    v_dot2c_f32_bf16 v9, s27, v52
    v_dot2c_f32_bf16 v10, s26, v53
    v_dot2c_f32_bf16 v11, s27, v53
    v_dot2c_f32_bf16 v12, s26, v54
    v_dot2c_f32_bf16 v13, s27, v54
    v_dot2c_f32_bf16 v14, s26, v55
    v_dot2c_f32_bf16 v15, s27, v55
    s_waitcnt vmcnt(3)
    v_dot2c_f32_bf16 v8, s26, v56
    v_dot2c_f32_bf16 v9, s27, v56
    v_dot2c_f32_bf16 v10, s26, v57
    v_dot2c_f32_bf16 v11, s27, v57
    v_dot2c_f32_bf16 v12, s26, v58
    v_dot2c_f32_bf16 v13, s27, v58
    v_dot2c_f32_bf16 v14, s26, v59
    v_dot2c_f32_bf16 v15, s27, v59
    s_waitcnt vmcnt(2)
    v_dot2c_f32_bf16 v8, s26, v60
    v_dot2c_f32_bf16 v9, s27, v60
    v_dot2c_f32_bf16 v10, s26, v61
    v_dot2c_f32_bf16 v11, s27, v61
    v_dot2c_f32_bf16 v12, s26, v62
    v_dot2c_f32_bf16 v13, s27, v62
    v_dot2c_f32_bf16 v14, s26, v63
    v_dot2c_f32_bf16 v15, s27, v63
    s_waitcnt vmcnt(1)
    v_dot2c_f32_bf16 v8, s26, v64
    v_dot2c_f32_bf16 v9, s27, v64
    v_dot2c_f32_bf16 v10, s26, v65
    v_dot2c_f32_bf16 v11, s27, v65
    v_dot2c_f32_bf16 v12, s26, v66
    v_dot2c_f32_bf16 v13, s27, v66
    v_dot2c_f32_bf16 v14, s26, v67
    v_dot2c_f32_bf16 v15, s27, v67
    s_waitcnt vmcnt(0)
    v_dot2c_f32_bf16 v8, s26, v68
    v_dot2c_f32_bf16 v9, s27, v68
    v_dot2c_f32_bf16 v10, s26, v69
    v_dot2c_f32_bf16 v11, s27, v69
    v_dot2c_f32_bf16 v12, s26, v70
    v_dot2c_f32_bf16 v13, s27, v70
    v_dot2c_f32_bf16 v14, s26, v71
    v_dot2c_f32_bf16 v15, s27, v71
    s_cmp_eq_u32 s20, 0
    s_cbranch_scc1 Lkf_cs2
    buffer_load_dword v100, v2, s[64:67], s34 offen
Lkf_cs2:
    v_mov_b32 v101, v2
    v_lshlrev_b32 v2, 5, v0
    v_and_b32 v4, 63, v0
    v_lshlrev_b32 v4, 2, v4
    v_add_u32 v3, 8192, v4
    s_nop 0
    ds_write_b128 v2, v[8:11]
    ds_write_b128 v2, v[12:15] offset:16
    s_waitcnt lgkmcnt(0)
    s_barrier
    s_cmp_ge_u32 s20, 1
    s_cbranch_scc1 Lkf_end
    ds_read2st64_b32 v[16:17], v4 offset0:0 offset1:1
    ds_read2st64_b32 v[18:19], v4 offset0:2 offset1:3
    ds_read2st64_b32 v[20:21], v4 offset0:4 offset1:5
    ds_read2st64_b32 v[22:23], v4 offset0:6 offset1:7
    ds_read2st64_b32 v[24:25], v4 offset0:8 offset1:9
    ds_read2st64_b32 v[26:27], v4 offset0:10 offset1:11
    ds_read2st64_b32 v[28:29], v4 offset0:12 offset1:13
    ds_read2st64_b32 v[30:31], v4 offset0:14 offset1:15
    s_waitcnt lgkmcnt(0)
    ds_read2st64_b32 v[32:33], v4 offset0:16 offset1:17
    ds_read2st64_b32 v[34:35], v4 offset0:18 offset1:19
    ds_read2st64_b32 v[36:37], v4 offset0:20 offset1:21
    ds_read2st64_b32 v[38:39], v4 offset0:22 offset1:23
    ds_read2st64_b32 v[40:41], v4 offset0:24 offset1:25
    ds_read2st64_b32 v[42:43], v4 offset0:26 offset1:27
    ds_read2st64_b32 v[44:45], v4 offset0:28 offset1:29
    ds_read2st64_b32 v[46:47], v4 offset0:30 offset1:31
    s_waitcnt lgkmcnt(0)
    ds_read2st64_b32 v[48:49], v3 offset0:0 offset1:1
    ds_read2st64_b32 v[50:51], v3 offset0:2 offset1:3
    ds_read2st64_b32 v[52:53], v3 offset0:4 offset1:5
    ds_read2st64_b32 v[54:55], v3 offset0:6 offset1:7
    ds_read2st64_b32 v[56:57], v3 offset0:8 offset1:9
    ds_read2st64_b32 v[58:59], v3 offset0:10 offset1:11
    ds_read2st64_b32 v[60:61], v3 offset0:12 offset1:13
    ds_read2st64_b32 v[62:63], v3 offset0:14 offset1:15
    s_waitcnt lgkmcnt(0)
    ds_read2st64_b32 v[64:65], v3 offset0:16 offset1:17
    ds_read2st64_b32 v[66:67], v3 offset0:18 offset1:19
    ds_read2st64_b32 v[68:69], v3 offset0:20 offset1:21
    ds_read2st64_b32 v[70:71], v3 offset0:22 offset1:23
    ds_read2st64_b32 v[72:73], v3 offset0:24 offset1:25
    ds_read2st64_b32 v[74:75], v3 offset0:26 offset1:27
    ds_read2st64_b32 v[76:77], v3 offset0:28 offset1:29
    ds_read2st64_b32 v[78:79], v3 offset0:30 offset1:31
    s_waitcnt lgkmcnt(0)
    s_lshl_b32 s23, s22, 8
    s_add_u32 s23, s23, 4227072
    s_add_u32 s24, s23, 7168
    v_add_f32 v16, v16, v32
    v_add_f32 v17, v17, v33
    v_add_f32 v18, v18, v34
    v_add_f32 v19, v19, v35
    v_add_f32 v20, v20, v36
    v_add_f32 v21, v21, v37
    v_add_f32 v22, v22, v38
    v_add_f32 v23, v23, v39
    v_add_f32 v24, v24, v40
    v_add_f32 v25, v25, v41
    v_add_f32 v26, v26, v42
    v_add_f32 v27, v27, v43
    v_add_f32 v28, v28, v44
    v_add_f32 v29, v29, v45
    v_add_f32 v30, v30, v46
    v_add_f32 v31, v31, v47
    v_add_f32 v16, v16, v24
    v_add_f32 v17, v17, v25
    v_add_f32 v18, v18, v26
    v_add_f32 v19, v19, v27
    v_add_f32 v20, v20, v28
    v_add_f32 v21, v21, v29
    v_add_f32 v22, v22, v30
    v_add_f32 v23, v23, v31
    v_add_f32 v16, v16, v20
    v_add_f32 v17, v17, v21
    v_add_f32 v18, v18, v22
    v_add_f32 v19, v19, v23
    v_add_f32 v16, v16, v18
    v_add_f32 v17, v17, v19
    v_add_f32 v16, v16, v17
    v_add_f32 v48, v48, v64
    v_add_f32 v49, v49, v65
    v_add_f32 v50, v50, v66
    v_add_f32 v51, v51, v67
    v_add_f32 v52, v52, v68
    v_add_f32 v53, v53, v69
    v_add_f32 v54, v54, v70
    v_add_f32 v55, v55, v71
    v_add_f32 v56, v56, v72
    v_add_f32 v57, v57, v73
    v_add_f32 v58, v58, v74
    v_add_f32 v59, v59, v75
    v_add_f32 v60, v60, v76
    v_add_f32 v61, v61, v77
    v_add_f32 v62, v62, v78
    v_add_f32 v63, v63, v79
    v_add_f32 v48, v48, v56
    v_add_f32 v49, v49, v57
    v_add_f32 v50, v50, v58
    v_add_f32 v51, v51, v59
    v_add_f32 v52, v52, v60
    v_add_f32 v53, v53, v61
    v_add_f32 v54, v54, v62
    v_add_f32 v55, v55, v63
    v_add_f32 v48, v48, v52
    v_add_f32 v49, v49, v53
    v_add_f32 v50, v50, v54
    v_add_f32 v51, v51, v55
    v_add_f32 v48, v48, v50
    v_add_f32 v49, v49, v51
    v_add_f32 v48, v48, v49
    buffer_store_dword v16, v4, s[12:15], s23 offen sc1
    buffer_store_dword v48, v4, s[12:15], s24 offen sc1
    buffer_load_dword v100, v101, s[64:67], s34 offen
    s_endpgm
Lkf_end:
    s_endpgm
Lcode_end:
.section .rodata,"a"
.p2align 6
.amdhsa_kernel sequential_preLN__linear_attn_block__swiglu_ffn__prompt_kernel
  .amdhsa_next_free_vgpr 256
  .amdhsa_next_free_sgpr 80
  .amdhsa_accum_offset 256
  .amdhsa_group_segment_fixed_size 0
  .amdhsa_kernarg_size 80
  .amdhsa_user_sgpr_count 2
  .amdhsa_user_sgpr_kernarg_segment_ptr 1
  .amdhsa_system_sgpr_workgroup_id_x 1
.end_amdhsa_kernel
```
